```python
import torch

def _softmax(x, axis=-1):
    return torch.softmax(x, dim=axis)
def _gelu(x):
    return torch.nn.functional.gelu(x, approximate="tanh")
def _silu(x):
    return torch.nn.functional.silu(x)
def _sigmoid(x):
    return torch.sigmoid(x)
def _layernorm(x, axis=-1, eps=1e-5):
    m = x.mean(dim=axis, keepdim=True)
    v = x.var(dim=axis, keepdim=True, unbiased=False)
    return (x - m) / torch.sqrt(v + eps)
def _scatter_add(tgt, idx, src, axis=0):
    return tgt.clone().index_add_(axis, idx, src)
def _segment_sum(src, seg, n):
    out = torch.zeros((n,) + src.shape[1:], dtype=src.dtype)
    return out.index_add_(0, seg, src)
def _pad(x, pw):
    flat = tuple(v for pair in reversed(pw) for v in pair)
    return torch.nn.functional.pad(x, flat)

kernel_name = 'sequential_preLN__sliding_block_cached__mixer_token_mlp__decode'

def setup_inputs():

    _w = (lambda a: (lambda t: t.to(torch.bfloat16) if t.is_floating_point() else t)(torch.as_tensor(a)))
    def _A_setup():
        B, Sq, D = 1, 1, 448
        Hq, Hkv, Sk, Dh = 16, 8, 65536, 256
        assert Hq % Hkv == 0, (Hq, Hkv)
        return {
            "x": _w((lambda *s: torch.randn(*s, dtype=torch.bfloat16) * 0.05)(B, Sq, D)),
            "k_cache": _w((lambda *s: torch.randn(*s, dtype=torch.bfloat16) * 3.2)(B, Hkv, Sk, Dh)),
            "v_cache": _w((lambda *s: torch.randn(*s, dtype=torch.bfloat16) * 0.8)(B, Hkv, Sk, Dh)),
            "wq": _w((lambda *s: torch.randn(*s, dtype=torch.bfloat16) * 3.2)(D, Hq * Dh) * (D ** -0.5)),
            "wo": _w((lambda *s: torch.randn(*s, dtype=torch.bfloat16) * 0.8)(Hq * Dh, D) * ((Hq * Dh) ** -0.5)),
        }
    _A_in = _A_setup()

    def _B_setup():
        B, S, D, F = 1, 1, 448, 1792
        return {
            "x": _w((lambda *s: torch.randn(*s, dtype=torch.bfloat16) * 0.05)(B, S, D)),
            "w1": _w((lambda *s: torch.randn(*s, dtype=torch.bfloat16) * 3.2)(S, F) * (S ** -0.5)),
            "b1": _w((lambda *s: torch.randn(*s, dtype=torch.bfloat16) * 3.2)(F) * 0.02),
            "w2": _w((lambda *s: torch.randn(*s, dtype=torch.bfloat16) * 0.4)(F, S) * (F ** -0.5)),
            "b2": _w((lambda *s: torch.randn(*s, dtype=torch.bfloat16) * 0.4)(S) * 0.02),
        }
    _B_in = _B_setup()

    return {
        "A_x": _A_in["x"],
        "A_k_cache": _A_in["k_cache"],
        "A_v_cache": _A_in["v_cache"],
        "A_wq": _A_in["wq"],
        "A_wo": _A_in["wo"],
        "B_x": _B_in["x"],
        "B_w1": _B_in["w1"],
        "B_b1": _B_in["b1"],
        "B_w2": _B_in["w2"],
        "B_b2": _B_in["b2"],
    }

def reference(A_x, A_k_cache, A_v_cache, A_wq, A_wo, B_x, B_w1, B_b1, B_w2, B_b2):
    def _A_ref(x, k_cache, v_cache, wq, wo):
        B, Sq, D = x.shape
        Hq, Dh = 16, 256
        Hkv, Sk = k_cache.shape[1], k_cache.shape[2]
        W = min(4096, max(256, Sk // 4))
        rep = Hq // Hkv
        q = (lambda x, *d: x.permute(*d))((x @ wq).reshape(B, Sq, Hq, Dh), 0, 2, 1, 3)
        k = (lambda x, n, axis: torch.repeat_interleave(x, n, dim=axis))(k_cache[:, :, Sk - W:, :], rep, axis=1)
        v = (lambda x, n, axis: torch.repeat_interleave(x, n, dim=axis))(v_cache[:, :, Sk - W:, :], rep, axis=1)
        scores = torch.einsum("bhqd,bhkd->bhqk", q, k) * (Dh ** -0.5)
        p = _softmax(scores, axis=-1)
        o = torch.einsum("bhqk,bhkd->bhqd", p, v)
        return (lambda x, *d: x.permute(*d))(o, 0, 2, 1, 3).reshape(B, Sq, Hq * Dh) @ wo

    def _B_ref(x, w1, b1, w2, b2):
        B, S, D = x.shape
        h = _layernorm(x, axis=-1)
        u = torch.einsum("bsd,sf->bdf", h, w1) + b1
        u = _gelu(u)
        y = torch.einsum("bdf,fs->bds", u, w2) + b2
        return (lambda x, *d: x.permute(*d))(y, 0, 2, 1)

    x = A_x
    h = x + _A_ref(_layernorm(x, axis=-1), A_k_cache, A_v_cache, A_wq, A_wo)
    h2 = h + _B_ref(_layernorm(h, axis=-1), B_w1, B_b1, B_w2, B_b2)
    return h2
```

```asm
; @launch grid=(256,1,1) block=(1024,1,1) lds=24576
.amdgcn_target "amdgcn-amd-amdhsa--gfx950"
.text
.globl sequential_preLN__sliding_block_cached__mixer_token_mlp__decode_kernel
.p2align 8
.type sequential_preLN__sliding_block_cached__mixer_token_mlp__decode_kernel,@function
sequential_preLN__sliding_block_cached__mixer_token_mlp__decode_kernel:
    s_cmp_ge_u32 s2, 256
    s_cbranch_scc1 L_exit
    s_load_dwordx16 s[16:31], s[0:1], 0
    s_load_dwordx8 s[32:39], s[0:1], 64
    s_load_dwordx2 s[40:41], s[0:1], 96
    v_lshrrev_b32 v1, 6, v0
    v_and_b32 v0, 63, v0
    s_and_b32 s3, s2, 7
    v_readfirstlane_b32 s5, v1
    s_lshr_b32 s4, s2, 3
    s_sub_u32 s5, s5, 1
    s_cmp_ge_u32 s5, 7
    s_cbranch_scc1 L_HS
    s_lshr_b32 s11, s4, 4
    s_mul_i32 s11, s11, 7
    s_add_u32 s11, s11, s5
    v_lshrrev_b32 v2, 3, v0
    v_lshlrev_b32 v1, 15, v2
    v_bfe_u32 v3, v0, 2, 1
    v_lshl_add_u32 v1, v3, 13, v1
    v_and_b32 v3, 3, v0
    v_lshl_add_u32 v1, v3, 4, v1
    s_lshl_b32 s12, s11, 6
    v_lshl_add_u32 v2, v2, 3, s12
    v_min_u32 v3, 55, v0
    v_lshlrev_b32 v3, 4, v3
    s_lshl_b32 s11, s11, 8
    s_add_u32 s11, s11, s3
    s_lshl_b32 s11, s11, 4
    s_and_b32 s8, s4, 15
    s_add_u32 s11, s11, s8
    s_lshl_b32 s11, s11, 6
    v_add_u32 v4, 0x4000, v1
    s_waitcnt lgkmcnt(0)
    s_add_u32 s22, s22, s11
    s_addc_u32 s23, s23, 0
    global_load_dwordx4 v[12:15], v3, s[16:17]
    global_load_dwordx2 v[16:17], v2, s[16:17]
    global_load_dwordx4 v[32:35], v1, s[22:23] nt
    global_load_dwordx4 v[36:39], v4, s[22:23] nt
    s_branch L_WQ
L_HS:
    s_lshl_b32 s6, s3, 5
    s_add_u32 s6, s6, s4
    s_sub_u32 s5, s5, 7
    s_lshl_b32 s11, s3, 25
    s_lshl_b32 s12, s4, 16
    s_add_u32 s11, s11, s12
    s_lshl_b32 s12, s5, 13
    s_add_u32 s11, s11, s12
    s_add_u32 s11, s11, 31461376
    s_cmp_eq_u32 s5, -8
    s_cbranch_scc1 L_H
    v_bfe_u32 v1, v0, 2, 2
    v_lshlrev_b32 v1, 9, v1
    v_lshrrev_b32 v3, 4, v0
    v_lshlrev_b32 v4, 2, v3
    v_and_b32 v5, 3, v0
    v_add_u32 v4, v4, v5
    v_lshlrev_b32 v6, 4, v4
    v_add_u32 v1, v1, v6
    v_lshlrev_b32 v2, 9, v3
    v_and_b32 v5, 15, v0
    v_lshl_add_u32 v2, v5, 4, v2
    s_waitcnt lgkmcnt(0)
    s_add_u32 s52, s18, s11
    s_addc_u32 s53, s19, 0
    s_add_u32 s54, s20, s11
    s_addc_u32 s55, s21, 0
    s_cmp_ge_u32 s5, 6
    s_cbranch_scc1 L_probe
L_S0:
    global_load_dwordx4 v[32:35], v1, s[52:53] offset:-4096 nt
    global_load_dwordx4 v[36:39], v1, s[52:53] offset:-3840 nt
    global_load_dwordx4 v[40:43], v1, s[52:53] offset:-2048 nt
    global_load_dwordx4 v[44:47], v1, s[52:53] offset:-1792 nt
    global_load_dwordx4 v[48:51], v1, s[52:53] offset:0 nt
    global_load_dwordx4 v[52:55], v1, s[52:53] offset:256 nt
    s_branch L_S
L_probe:
    s_sub_u32 s12, s4, 8
    s_cmp_ge_u32 s12, 8
    s_cbranch_scc1 L_S0
    s_lshr_b32 s11, s6, 6
    s_lshl_b32 s11, s11, 14
    s_and_b32 s42, s6, 63
    s_lshl_b32 s42, s42, 7
    s_add_u32 s11, s11, s42
    s_and_b32 s43, s5, 1
    s_lshl_b32 s42, s43, 13
    s_add_u32 s11, s11, s42
    s_add_u32 s11, s11, 1835008
    s_lshl_b32 s43, s43, 2
    v_mov_b32 v5, s43
    s_memtime s[44:45]
    s_waitcnt lgkmcnt(0)
    s_load_dword s48, s[40:41], s11
    s_waitcnt lgkmcnt(0)
    s_memtime s[46:47]
    s_waitcnt lgkmcnt(0)
    s_sub_u32 s48, s46, s44
    v_mov_b32 v4, s48
    ds_write_b32 v5, v4 offset:6160
    s_branch L_S0
L_H:
    s_setprio 3
    v_lshlrev_b32 v1, 4, v0
    s_getreg_b32 s7, hwreg(HW_REG_XCC_ID, 0, 3)
    s_lshl_b32 s12, s6, 7
    v_mov_b32 v8, 0
    v_mov_b32 v9, 0
    v_mov_b32 v10, 0
    v_mov_b32 v11, 0
    v_and_b32 v2, 31, v0
    v_lshlrev_b32 v2, 4, v2
    ds_write_b128 v2, v[8:11] offset:3584
    s_lshl_b32 s11, s3, 13
    s_add_u32 s11, s11, 69632
    v_add_u32 v12, s11, v1
    v_and_b32 v3, 7, v0
    v_lshlrev_b32 v3, 5, v3
    v_lshrrev_b32 v2, 5, v0
    v_lshl_add_u32 v3, v2, 4, v3
    s_lshl_b32 s11, s6, 8
    s_add_u32 s11, s11, 65536
    v_add_u32 v3, s11, v3
    s_mov_b32 s50, 0xff
    s_mov_b32 s51, 0xff
    s_waitcnt lgkmcnt(0)
    s_load_dword s13, s[40:41], 0
    s_load_dword s48, s[16:17], 0
    s_add_u32 s54, s40, s12
    s_addc_u32 s55, s41, 0
    s_mov_b64 exec, s[50:51]
    global_load_dword v14, v3, s[40:41] nt
    s_mov_b64 exec, -1
    v_mov_b32 v2, 32768
    s_mov_b64 exec, 1
    global_load_dword v14, v2, s[54:55] nt
    s_mov_b64 exec, -1
    s_waitcnt lgkmcnt(0)
    s_mul_i32 s48, s48, 0x2545f490
    s_add_u32 s14, s13, 0x9e3779b0
    s_add_u32 s14, s14, s48
    s_and_b32 s14, s14, -16
    s_or_b32 s15, s14, s7
    v_mov_b32 v9, s15
    v_mov_b32 v11, s15
    v_mov_b32 v13, 0
    s_branch L_H2
L_WQ:
    s_setprio 2
    s_lshl_b32 s6, s3, 5
    s_add_u32 s6, s6, s4
    v_mov_b32 v4, -2
    v_mov_b32 v5, -2
    v_mov_b32 v6, -2
    v_mov_b32 v7, -2
    s_lshl_b32 s12, s6, 11
    s_add_u32 s13, s12, 131072
    s_lshl_b32 s11, s5, 10
    s_add_u32 s11, s11, s13
    s_cmp_lt_u32 s5, 2
    s_cselect_b32 s11, s11, s13
    s_cselect_b64 exec, -1, 1
    v_lshl_add_u32 v1, v0, 4, s11
    global_load_dwordx4 v[44:47], v1, s[40:41] nt
    global_store_dwordx4 v1, v[4:7], s[40:41]
    s_mov_b64 exec, -1
    v_and_b32 v3, 7, v0
    v_lshlrev_b32 v40, 5, v3
    v_bfe_u32 v2, v0, 4, 1
    v_lshl_add_u32 v40, v2, 4, v40
    v_lshrrev_b32 v2, 5, v0
    v_lshl_add_u32 v40, v2, 3, v40
    s_lshl_b32 s11, s5, 8
    s_add_u32 s11, s11, s12
    s_add_u32 s11, s11, 131072
    v_add_u32 v40, s11, v40
    s_mov_b32 s56, 0x00ff00ff
    s_mov_b32 s57, 0x00ff00ff
    v_and_b32 v4, 1, v0
    v_lshlrev_b32 v4, 4, v4
    v_mov_b32 v5, 0xffff
    v_lshlrev_b32 v4, v4, v5
    v_bfe_u32 v5, v0, 1, 2
    v_cmp_eq_u32 s[44:45], 0, v5
    v_cmp_eq_u32 s[46:47], 1, v5
    v_cmp_eq_u32 s[48:49], 2, v5
    v_cmp_eq_u32 s[50:51], 3, v5
    v_cndmask_b32 v8, 0, v4, s[44:45]
    v_cndmask_b32 v9, 0, v4, s[46:47]
    v_cndmask_b32 v10, 0, v4, s[48:49]
    v_cndmask_b32 v11, 0, v4, s[50:51]
    s_mov_b32 s12, -1
    s_mov_b32 s13, 0x00ffffff
    v_bfe_u32 v4, v0, 2, 1
    v_lshrrev_b32 v5, 5, v0
    v_lshl_add_u32 v4, v4, 1, v5
    s_lshl_b32 s11, s5, 2
    v_add_u32 v4, s11, v4
    v_lshlrev_b32 v7, 7, v4
    v_and_b32 v4, 3, v0
    v_lshl_add_u32 v7, v4, 5, v7
    v_bfe_u32 v4, v0, 4, 1
    v_lshl_add_u32 v7, v4, 4, v7
    s_mov_b32 s14, 0x01000100
    s_mov_b32 s15, 0x03020302
    s_mov_b32 s42, 0xffff0000
    s_mov_b32 s43, 991054117
    v_mov_b32 v4, 0
    v_mov_b32 v6, 0
    s_waitcnt vmcnt(5)
    v_lshlrev_b32 v20, 16, v12
    v_and_b32 v21, s42, v12
    v_lshlrev_b32 v22, 16, v13
    v_and_b32 v23, s42, v13
    v_lshlrev_b32 v24, 16, v14
    v_and_b32 v25, s42, v14
    v_lshlrev_b32 v26, 16, v15
    v_and_b32 v27, s42, v15
    v_pk_add_f32 v[28:29], v[20:21], v[22:23]
    v_pk_add_f32 v[30:31], v[24:25], v[26:27]
    v_pk_add_f32 v[28:29], v[28:29], v[30:31]
    s_mov_b64 exec, s[12:13]
    v_add_f32 v4, v28, v29
    s_mov_b64 exec, -1
    s_nop 0
    v_add_f32_dpp v4, v4, v4 quad_perm:[1,0,3,2] row_mask:0xf bank_mask:0xf
    s_nop 1
    v_add_f32_dpp v4, v4, v4 quad_perm:[2,3,0,1] row_mask:0xf bank_mask:0xf
    s_nop 1
    v_add_f32_dpp v4, v4, v4 row_half_mirror row_mask:0xf bank_mask:0xf
    s_nop 1
    v_add_f32_dpp v4, v4, v4 row_mirror row_mask:0xf bank_mask:0xf
    v_mov_b32 v5, v4
    s_nop 1
    v_permlane16_swap_b32 v5, v4
    v_add_f32 v4, v4, v5
    v_mov_b32 v5, v4
    s_nop 1
    v_permlane32_swap_b32 v5, v4
    v_add_f32 v4, v4, v5
    v_mul_f32 v4, s43, v4
    v_pk_add_f32 v[20:21], v[20:21], v[4:5] op_sel_hi:[1,0] neg_lo:[0,1] neg_hi:[0,1]
    v_pk_add_f32 v[22:23], v[22:23], v[4:5] op_sel_hi:[1,0] neg_lo:[0,1] neg_hi:[0,1]
    v_pk_add_f32 v[24:25], v[24:25], v[4:5] op_sel_hi:[1,0] neg_lo:[0,1] neg_hi:[0,1]
    v_pk_add_f32 v[26:27], v[26:27], v[4:5] op_sel_hi:[1,0] neg_lo:[0,1] neg_hi:[0,1]
    v_pk_mul_f32 v[28:29], v[20:21], v[20:21]
    v_pk_fma_f32 v[28:29], v[22:23], v[22:23], v[28:29]
    v_pk_fma_f32 v[28:29], v[24:25], v[24:25], v[28:29]
    v_pk_fma_f32 v[28:29], v[26:27], v[26:27], v[28:29]
    s_mov_b64 exec, s[12:13]
    v_add_f32 v6, v28, v29
    s_mov_b64 exec, -1
    s_nop 0
    v_add_f32_dpp v6, v6, v6 quad_perm:[1,0,3,2] row_mask:0xf bank_mask:0xf
    s_nop 1
    v_add_f32_dpp v6, v6, v6 quad_perm:[2,3,0,1] row_mask:0xf bank_mask:0xf
    s_nop 1
    v_add_f32_dpp v6, v6, v6 row_half_mirror row_mask:0xf bank_mask:0xf
    s_nop 1
    v_add_f32_dpp v6, v6, v6 row_mirror row_mask:0xf bank_mask:0xf
    v_mov_b32 v5, v6
    s_nop 1
    v_permlane16_swap_b32 v5, v6
    v_add_f32 v6, v6, v5
    v_mov_b32 v5, v6
    s_nop 1
    v_permlane32_swap_b32 v5, v6
    v_add_f32 v6, v6, v5
    v_mul_f32 v6, s43, v6
    v_cvt_pk_bf16_f32 v4, v4, v4
    v_lshlrev_b32 v4, 16, v4
    v_cvt_pk_bf16_f32 v6, v6, v6
    v_lshlrev_b32 v6, 16, v6
    v_add_f32 v6, 925353388, v6
    v_cvt_pk_bf16_f32 v6, v6, v6
    v_lshlrev_b32 v6, 16, v6
    v_sqrt_f32 v6, v6
    s_nop 0
    v_cvt_pk_bf16_f32 v6, v6, v6
    v_lshlrev_b32 v6, 16, v6
    v_rcp_f32 v6, v6
    s_waitcnt vmcnt(4)
    v_lshlrev_b32 v20, 16, v16
    v_and_b32 v21, s42, v16
    v_lshlrev_b32 v22, 16, v17
    v_and_b32 v23, s42, v17
    v_pk_add_f32 v[20:21], v[20:21], v[4:5] op_sel_hi:[1,0] neg_lo:[0,1] neg_hi:[0,1]
    v_pk_add_f32 v[22:23], v[22:23], v[4:5] op_sel_hi:[1,0] neg_lo:[0,1] neg_hi:[0,1]
    v_cvt_pk_bf16_f32 v16, v20, v21
    v_cvt_pk_bf16_f32 v17, v22, v23
    v_lshlrev_b32 v20, 16, v16
    v_and_b32 v21, s42, v16
    v_lshlrev_b32 v22, 16, v17
    v_and_b32 v23, s42, v17
    v_pk_mul_f32 v[20:21], v[20:21], v[6:7] op_sel_hi:[1,0]
    v_pk_mul_f32 v[22:23], v[22:23], v[6:7] op_sel_hi:[1,0]
    v_cvt_pk_bf16_f32 v16, v20, v21
    v_cvt_pk_bf16_f32 v17, v22, v23
    v_perm_b32 v4, v16, v16, s14
    v_and_b32 v48, v4, v8
    v_and_b32 v49, v4, v9
    v_and_b32 v50, v4, v10
    v_and_b32 v51, v4, v11
    v_perm_b32 v4, v16, v16, s15
    v_and_b32 v52, v4, v8
    v_and_b32 v53, v4, v9
    v_and_b32 v54, v4, v10
    v_and_b32 v55, v4, v11
    v_perm_b32 v4, v17, v17, s14
    v_and_b32 v56, v4, v8
    v_and_b32 v57, v4, v9
    v_and_b32 v58, v4, v10
    v_and_b32 v59, v4, v11
    v_perm_b32 v4, v17, v17, s15
    v_and_b32 v60, v4, v8
    v_and_b32 v61, v4, v9
    v_and_b32 v62, v4, v10
    v_and_b32 v63, v4, v11
    s_mov_b32 s44, 0xf0f0f0f0
    s_mov_b32 s45, 0xf0f0f0f0
    s_mov_b32 s46, 0x00ff00ff
    s_mov_b32 s47, 0xff00ff00
    s_waitcnt vmcnt(3)
    v_mfma_f32_16x16x32_bf16 v[20:23], v[48:51], v[32:35], 0
    v_mfma_f32_16x16x32_bf16 v[24:27], v[52:55], v[32:35], 0
    s_waitcnt vmcnt(2)
    v_mfma_f32_16x16x32_bf16 v[20:23], v[56:59], v[36:39], v[20:23]
    v_mfma_f32_16x16x32_bf16 v[24:27], v[60:63], v[36:39], v[24:27]
    s_nop 7
    v_cndmask_b32 v20, v20, v24, s[44:45]
    v_cndmask_b32 v21, v21, v25, s[44:45]
    v_cndmask_b32 v22, v22, v26, s[44:45]
    v_cndmask_b32 v23, v23, v27, s[44:45]
    s_mov_b64 exec, s[46:47]
    ds_write_b128 v7, v[20:23] offset:0
    s_waitcnt lgkmcnt(0)
    s_barrier
    s_barrier
    s_mov_b64 exec, -1
    s_setprio 0
    s_lshl_b32 s11, s3, 9
    s_bfe_u32 s12, s4, 0x10003
    s_lshl_b32 s12, s12, 8
    s_add_u32 s11, s11, s12
    s_lshr_b32 s12, s4, 4
    s_lshl_b32 s12, s12, 7
    s_add_u32 s11, s11, s12
    s_bfe_u32 s12, s4, 0x10001
    s_lshl_b32 s12, s12, 6
    s_add_u32 s11, s11, s12
    s_and_b32 s12, s4, 1
    s_lshl_b32 s12, s12, 5
    s_add_u32 s11, s11, s12
    s_bfe_u32 s12, s4, 0x10002
    s_lshl_b32 s12, s12, 2
    s_add_u32 s11, s11, s12
    v_lshrrev_b32 v2, 4, v0
    v_lshlrev_b32 v2, 3, v2
    v_bfe_u32 v1, v0, 3, 1
    v_add3_u32 v2, v2, v1, s11
    v_mul_u32_u24 v2, 896, v2
    v_and_b32 v3, 7, v0
    v_lshl_add_u32 v2, v3, 4, v2
    s_lshl_b32 s12, s5, 7
    v_add_u32 v2, s12, v2
    v_lshlrev_b32 v1, 4, v0
    v_mov_b32 v4, 0
    v_mov_b32 v5, 0
    v_mov_b32 v6, 0
    v_mov_b32 v7, 0
    ds_write_b128 v1, v[4:7] offset:8192
    ds_write_b128 v1, v[4:7] offset:9216
    s_waitcnt vmcnt(0) lgkmcnt(0)
    s_barrier
    s_barrier
    s_barrier
    s_barrier
    s_barrier
    ds_read_b32 v3, v5 offset:6144
    s_waitcnt lgkmcnt(0)
    v_readfirstlane_b32 s9, v3
    s_nop 0
    s_cmp_eq_u32 s9, 1
    s_cselect_b64 s[48:49], s[56:57], 0
    s_cselect_b64 s[50:51], 0, s[56:57]
    s_barrier
    s_barrier
    global_load_dwordx4 v[32:35], v2, s[24:25] offset:0 nt
    global_load_dwordx4 v[36:39], v2, s[24:25] offset:1792 nt
    s_barrier
    s_waitcnt vmcnt(0)
    s_barrier
    ds_read_b128 v[48:51], v1 offset:8192
    ds_read_b128 v[52:55], v1 offset:9216
    s_waitcnt lgkmcnt(1)
    v_mfma_f32_16x16x32_bf16 v[20:23], v[48:51], v[32:35], 0
    s_waitcnt lgkmcnt(0)
    v_mfma_f32_16x16x32_bf16 v[20:23], v[52:55], v[36:39], v[20:23]
    s_nop 7
    v_permlane32_swap_b32 v20, v22
    v_permlane32_swap_b32 v21, v23
    s_nop 0
    v_add_f32_dpp v20, v22, v20 row_ror:8 row_mask:0xf bank_mask:0xf
    v_add_f32_dpp v21, v23, v21 row_ror:8 row_mask:0xf bank_mask:0xf
    v_or_b32 v20, 1, v20
    v_or_b32 v21, 1, v21
    s_mov_b64 exec, s[48:49]
    global_store_dwordx2 v40, v[20:21], s[40:41]
    s_mov_b64 exec, s[50:51]
    global_store_dwordx2 v40, v[20:21], s[40:41] sc1
    s_endpgm
L_H2:
    s_mov_b32 s8, s4
    s_barrier
    ds_read_b128 v[16:19], v1 offset:0
    ds_read_b128 v[20:23], v1 offset:1024
    ds_read_b128 v[24:27], v1 offset:2048
    ds_read_b128 v[28:31], v1 offset:3072
    s_sub_u32 s12, s4, 8
    s_cmp_ge_u32 s12, 8
    s_cbranch_scc1 L_H_nv
    ds_read_b64 v[6:7], v13 offset:6160
    s_waitcnt lgkmcnt(0)
    v_cmp_gt_u32 vcc, v6, v7
    s_nop 1
    v_addc_co_u32 v13, vcc, 0, v13, vcc
    v_lshl_or_b32 v9, v13, 3, v9
    v_mov_b32 v11, v9
L_H_nv:
    s_waitcnt lgkmcnt(0)
    v_pk_add_f32 v[16:17], v[16:17], v[20:21]
    v_pk_add_f32 v[18:19], v[18:19], v[22:23]
    v_pk_add_f32 v[24:25], v[24:25], v[28:29]
    v_pk_add_f32 v[26:27], v[26:27], v[30:31]
    v_pk_add_f32 v[16:17], v[16:17], v[24:25]
    v_pk_add_f32 v[18:19], v[18:19], v[26:27]
    s_nop 1
    v_permlane32_swap_b32 v16, v18
    v_permlane32_swap_b32 v17, v19
    v_pk_add_f32 v[16:17], v[16:17], v[18:19]
    s_nop 1
    v_add_f32_dpp v16, v16, v16 row_ror:8 row_mask:0xf bank_mask:0xf
    v_add_f32_dpp v17, v17, v17 row_ror:8 row_mask:0xf bank_mask:0xf
    v_mov_b32 v18, v16
    v_mov_b32 v19, v17
    s_nop 0
    v_permlane16_swap_b32 v18, v16
    v_permlane16_swap_b32 v19, v17
    v_add_f32 v8, v16, v18
    v_add_f32 v10, v17, v19
    s_mov_b64 exec, s[50:51]
    global_store_dwordx4 v3, v[8:11], s[40:41]
    s_mov_b64 exec, -1
    v_readfirstlane_b32 s15, v9
    s_barrier
    s_sub_u32 s12, s4, 16
    s_cmp_ge_u32 s12, 4
    s_cbranch_scc1 L_H_1
    s_getpc_b64 s[56:57]
L_pc:
    s_sub_u32 s56, s56, L_pc-sequential_preLN__sliding_block_cached__mixer_token_mlp__decode_kernel
    s_subb_u32 s57, s57, 0
    v_lshl_add_u32 v2, v0, 2, s12
    v_lshlrev_b32 v2, 7, v2
    v_min_u32 v2, L_exit-sequential_preLN__sliding_block_cached__mixer_token_mlp__decode_kernel, v2
    s_mov_b64 exec, 0xffffff
    global_load_dword v14, v2, s[56:57]
    s_mov_b64 exec, -1
L_H_1:
    s_barrier
    global_load_dwordx4 v[64:67], v12, s[40:41] offset:-4096 sc1
    global_load_dwordx4 v[68:71], v12, s[40:41] offset:-3072 sc1
    global_load_dwordx4 v[72:75], v12, s[40:41] offset:-2048 sc1
    global_load_dwordx4 v[76:79], v12, s[40:41] offset:-1024 sc1
    global_load_dwordx4 v[80:83], v12, s[40:41] offset:0 sc1
    global_load_dwordx4 v[84:87], v12, s[40:41] offset:1024 sc1
    global_load_dwordx4 v[88:91], v12, s[40:41] offset:2048 sc1
    global_load_dwordx4 v[92:95], v12, s[40:41] offset:3072 sc1
    s_xor_b32 s12, s14, 1
    v_mov_b32 v5, s12
    v_mov_b32 v7, s12
    v_add_u32 v2, 32768, v1
    s_mov_b64 exec, 3
    global_store_dwordx4 v2, v[4:7], s[54:55]
    s_mov_b64 exec, -1
    s_min_u32 s43, s8, 27
    v_and_b32 v17, 7, v0
    v_lshrrev_b32 v16, 5, v0
    v_lshl_add_u32 v19, v17, 1, v16
    s_lshl_b32 s12, s43, 4
    v_add_u32 v19, s12, v19
    v_lshlrev_b32 v19, 1, v19
    global_load_ushort v31, v19, s[16:17]
    s_barrier
    s_lshl_b32 s11, s3, 12
    s_add_u32 s11, s11, 32772
    v_and_b32 v15, 31, v0
    v_lshlrev_b32 v15, 7, v15
    v_add_u32 v15, s11, v15
    s_barrier
    global_load_dwordx4 v[96:99], v12, s[40:41] offset:-4096 sc1
    global_load_dwordx4 v[100:103], v12, s[40:41] offset:-3072 sc1
    global_load_dwordx4 v[104:107], v12, s[40:41] offset:-2048 sc1
    global_load_dwordx4 v[108:111], v12, s[40:41] offset:-1024 sc1
    global_load_dwordx4 v[112:115], v12, s[40:41] offset:0 sc1
    global_load_dwordx4 v[116:119], v12, s[40:41] offset:1024 sc1
    global_load_dwordx4 v[120:123], v12, s[40:41] offset:2048 sc1
    global_load_dwordx4 v[124:127], v12, s[40:41] offset:3072 sc1
    s_barrier
    s_mov_b32 s42, 1035512379
    v_lshrrev_b32 v16, 5, v0
    v_lshlrev_b32 v46, 4, v16
    v_add_u32 v46, 32768, v46
    v_mov_b32 v53, s14
    v_mov_b32 v55, s14
    s_min_u32 s43, s8, 27
    v_lshrrev_b32 v45, 2, v0
    s_lshl_b32 s11, s3, 5
    v_add_u32 v45, s11, v45
    v_lshlrev_b32 v13, 11, v45
    v_and_b32 v20, 3, v0
    v_lshl_add_u32 v13, v20, 4, v13
    s_lshl_b32 s12, s43, 6
    s_add_u32 s12, s12, 131072
    v_add_u32 v24, s12, v13
    v_add_u32 v25, 0x8000, v24
    s_lshl_b32 s12, s6, 11
    s_add_u32 s12, s12, 131072
    v_add_u32 v13, s12, v1
    v_lshlrev_b32 v45, 7, v45
    s_bfe_u32 s12, s4, 0x10003
    s_lshl_b32 s12, s12, 4
    s_add_u32 s12, s12, 32768
    v_add_u32 v45, s12, v45
    v_lshrrev_b32 v18, 4, v0
    v_and_b32 v47, 1, v18
    v_lshl_add_u32 v47, v20, 1, v47
    v_lshl_add_u32 v47, v16, 3, v47
    v_lshlrev_b32 v47, 7, v47
    v_bfe_u32 v21, v0, 2, 2
    v_mul_u32_u24 v21, 36, v21
    v_add_u32 v47, v47, v21
    s_lshr_b32 s12, s43, 3
    s_lshl_b32 s12, s12, 14
    s_and_b32 s11, s43, 7
    s_lshl_b32 s11, s11, 10
    s_add_u32 s12, s12, s11
    s_add_u32 s12, s12, 1310720
    v_bfe_u32 v26, v0, 2, 2
    v_lshlrev_b32 v26, 16, v26
    v_lshl_add_u32 v20, v20, 2, v18
    v_lshl_add_u32 v26, v20, 3, v26
    s_lshl_b32 s11, s3, 7
    s_add_u32 s11, s11, s12
    v_add_u32 v26, s11, v26
    v_add_u32 v27, 262144, v26
    s_lshl_b32 s11, s3, 16
    s_add_u32 s12, s12, s11
    v_add_u32 v28, s12, v1
    s_lshl_b32 s12, s3, 5
    s_add_u32 s12, s12, s43
    s_lshl_b32 s12, s12, 6
    s_add_u32 s12, s12, 1179648
    v_lshl_add_u32 v29, v0, 3, s12
    s_mov_b32 s56, 1
    s_mov_b32 s57, 1
    v_bfe_u32 v30, v0, 2, 2
    v_lshlrev_b32 v30, 7, v30
    s_lshl_b32 s12, s3, 10
    s_add_u32 s12, s12, 1196032
    v_add_u32 v30, s12, v30
    s_waitcnt vmcnt(8)
    v_xor_b32 v16, s15, v65
    v_xor_b32 v17, s15, v69
    v_xor_b32 v18, s15, v73
    v_xor_b32 v19, s15, v77
    v_xor_b32 v20, s15, v81
    v_xor_b32 v21, s15, v85
    v_xor_b32 v22, s15, v89
    v_xor_b32 v23, s15, v93
    v_bitop3_b32 v16, v67, s15, v16 bitop3:0xbe
    v_bitop3_b32 v17, v71, s15, v17 bitop3:0xbe
    v_bitop3_b32 v18, v75, s15, v18 bitop3:0xbe
    v_bitop3_b32 v19, v79, s15, v19 bitop3:0xbe
    v_bitop3_b32 v20, v83, s15, v20 bitop3:0xbe
    v_bitop3_b32 v21, v87, s15, v21 bitop3:0xbe
    v_bitop3_b32 v22, v91, s15, v22 bitop3:0xbe
    v_bitop3_b32 v23, v95, s15, v23 bitop3:0xbe
    v_cmp_lt_u32 s[18:19], 15, v16
    v_cmp_lt_u32 s[20:21], 15, v17
    v_cmp_lt_u32 s[22:23], 15, v18
    v_cmp_lt_u32 s[24:25], 15, v19
    v_cmp_lt_u32 s[26:27], 15, v20
    v_cmp_lt_u32 s[28:29], 15, v21
    v_cmp_lt_u32 s[30:31], 15, v22
    v_cmp_lt_u32 s[32:33], 15, v23
    v_or3_b32 v4, v16, v17, v18
    v_or3_b32 v5, v19, v20, v21
    v_or3_b32 v4, v4, v22, v23
    v_or_b32 v4, v4, v5
    v_cmp_lt_u32 vcc, 15, v4
    s_mov_b32 s10, 64
    s_cbranch_vccz L_H_got
    s_waitcnt vmcnt(0)
    v_mov_b32 v64, v96
    v_mov_b32 v65, v97
    v_mov_b32 v66, v98
    v_mov_b32 v67, v99
    v_mov_b32 v68, v100
    v_mov_b32 v69, v101
    v_mov_b32 v70, v102
    v_mov_b32 v71, v103
    v_mov_b32 v72, v104
    v_mov_b32 v73, v105
    v_mov_b32 v74, v106
    v_mov_b32 v75, v107
    v_mov_b32 v76, v108
    v_mov_b32 v77, v109
    v_mov_b32 v78, v110
    v_mov_b32 v79, v111
    v_mov_b32 v80, v112
    v_mov_b32 v81, v113
    v_mov_b32 v82, v114
    v_mov_b32 v83, v115
    v_mov_b32 v84, v116
    v_mov_b32 v85, v117
    v_mov_b32 v86, v118
    v_mov_b32 v87, v119
    v_mov_b32 v88, v120
    v_mov_b32 v89, v121
    v_mov_b32 v90, v122
    v_mov_b32 v91, v123
    v_mov_b32 v92, v124
    v_mov_b32 v93, v125
    v_mov_b32 v94, v126
    v_mov_b32 v95, v127
    s_mov_b32 s10, 64
    s_waitcnt vmcnt(0)
L_H_poll:
    v_xor_b32 v16, s15, v65
    v_xor_b32 v17, s15, v69
    v_xor_b32 v18, s15, v73
    v_xor_b32 v19, s15, v77
    v_xor_b32 v20, s15, v81
    v_xor_b32 v21, s15, v85
    v_xor_b32 v22, s15, v89
    v_xor_b32 v23, s15, v93
    v_bitop3_b32 v16, v67, s15, v16 bitop3:0xbe
    v_bitop3_b32 v17, v71, s15, v17 bitop3:0xbe
    v_bitop3_b32 v18, v75, s15, v18 bitop3:0xbe
    v_bitop3_b32 v19, v79, s15, v19 bitop3:0xbe
    v_bitop3_b32 v20, v83, s15, v20 bitop3:0xbe
    v_bitop3_b32 v21, v87, s15, v21 bitop3:0xbe
    v_bitop3_b32 v22, v91, s15, v22 bitop3:0xbe
    v_bitop3_b32 v23, v95, s15, v23 bitop3:0xbe
    v_cmp_lt_u32 s[18:19], 15, v16
    v_cmp_lt_u32 s[20:21], 15, v17
    v_cmp_lt_u32 s[22:23], 15, v18
    v_cmp_lt_u32 s[24:25], 15, v19
    v_cmp_lt_u32 s[26:27], 15, v20
    v_cmp_lt_u32 s[28:29], 15, v21
    v_cmp_lt_u32 s[30:31], 15, v22
    v_cmp_lt_u32 s[32:33], 15, v23
    v_or3_b32 v4, v16, v17, v18
    v_or3_b32 v5, v19, v20, v21
    v_or3_b32 v4, v4, v22, v23
    v_or_b32 v4, v4, v5
    v_cmp_lt_u32 vcc, 15, v4
    s_cbranch_vccz L_H_got
    s_mov_b64 exec, s[18:19]
    global_load_dwordx4 v[64:67], v12, s[40:41] offset:-4096 sc1
    s_mov_b64 exec, s[20:21]
    global_load_dwordx4 v[68:71], v12, s[40:41] offset:-3072 sc1
    s_mov_b64 exec, s[22:23]
    global_load_dwordx4 v[72:75], v12, s[40:41] offset:-2048 sc1
    s_mov_b64 exec, s[24:25]
    global_load_dwordx4 v[76:79], v12, s[40:41] offset:-1024 sc1
    s_mov_b64 exec, s[26:27]
    global_load_dwordx4 v[80:83], v12, s[40:41] offset:0 sc1
    s_mov_b64 exec, s[28:29]
    global_load_dwordx4 v[84:87], v12, s[40:41] offset:1024 sc1
    s_mov_b64 exec, s[30:31]
    global_load_dwordx4 v[88:91], v12, s[40:41] offset:2048 sc1
    s_mov_b64 exec, s[32:33]
    global_load_dwordx4 v[92:95], v12, s[40:41] offset:3072 sc1
    s_mov_b64 exec, -1
    s_waitcnt vmcnt(0)
    s_sub_u32 s10, s10, 1
    s_cbranch_scc0 L_H_poll
    s_branch L_H_far
L_H_got:
    global_load_dword v44, v15, s[40:41] sc1
    v_add_f32 v16, v64, v80
    v_add_f32 v17, v66, v82
    v_cvt_pk_bf16_f32 v20, v16, v17
    v_add_f32 v16, v68, v84
    v_add_f32 v17, v70, v86
    v_cvt_pk_bf16_f32 v21, v16, v17
    v_add_f32 v16, v72, v88
    v_add_f32 v17, v74, v90
    v_cvt_pk_bf16_f32 v22, v16, v17
    v_add_f32 v16, v76, v92
    v_add_f32 v17, v78, v94
    v_cvt_pk_bf16_f32 v23, v16, v17
    v_and_b32 v4, 7, v4
    v_cmp_ne_u32 vcc, 0, v4
    v_lshlrev_b32 v2, 2, v0
    s_cmp_eq_u64 vcc, 0
    s_cselect_b32 s9, 1, 0
    ds_write2st64_b32 v2, v20, v21 offset0:16 offset1:17
    ds_write2st64_b32 v2, v22, v23 offset0:18 offset1:19
    v_mov_b32 v4, s9
    v_mov_b32 v5, s14
    v_mov_b32 v6, s13
    v_mov_b32 v2, 0
    ds_write_b96 v2, v[4:6] offset:6144
    s_cbranch_scc0 L_H_span
L_H_go:
    s_waitcnt lgkmcnt(0)
    s_barrier
    v_bfe_u32 v16, v73, 3, 1
    v_bfe_u32 v17, v77, 3, 1
    v_add_u32 v16, v16, v17
    s_nop 0
    v_readlane_b32 s44, v16, 0
    v_readlane_b32 s45, v16, 16
    v_readlane_b32 s46, v16, 32
    v_readlane_b32 s47, v16, 48
    s_add_u32 s44, s44, s45
    s_add_u32 s46, s46, s47
    s_add_u32 s44, s44, s46
    s_cmp_gt_u32 s44, 4
    s_cselect_b32 s46, 0x2000, 0
    s_sub_u32 s45, 8, s44
    s_bitcmp1_b32 s7, 2
    s_cselect_b32 s44, s45, s44
    s_cselect_b32 s45, 0x2000, 0
    s_or_b32 s44, s44, s45
    s_cmp_lg_u32 s4, 0
    s_cbranch_scc1 L_H_sd
    v_mov_b32 v16, s44
    v_mov_b32 v17, s14
    s_lshl_b32 s12, s3, 7
    s_add_u32 s12, s12, 1196032
    v_lshl_add_u32 v18, v0, 10, s12
    s_mov_b64 exec, 0xff
    global_store_dwordx2 v18, v[16:17], s[40:41] sc1
    s_mov_b64 exec, -1
L_H_sd:
    v_add_u32 v14, s46, v28
    s_cmp_eq_u32 s9, 1
    s_cselect_b64 s[44:45], 0xff, 0
    s_cselect_b64 s[46:47], 0, 0xff
    s_barrier
    ds_read_b128 v[48:51], v1 offset:5120
    s_waitcnt lgkmcnt(0)
    v_max3_f32 v52, v48, v49, v50
    v_max_f32 v52, v52, v51
    s_nop 1
    v_max_f32_dpp v52, v52, v52 quad_perm:[1,0,3,2] row_mask:0xf bank_mask:0xf
    s_nop 1
    v_max_f32_dpp v52, v52, v52 quad_perm:[2,3,0,1] row_mask:0xf bank_mask:0xf
    s_nop 1
    v_max_f32_dpp v52, v52, v52 row_half_mirror row_mask:0xf bank_mask:0xf
    s_nop 1
    v_max_f32_dpp v52, v52, v52 row_mirror row_mask:0xf bank_mask:0xf
    v_mov_b32 v5, v52
    s_nop 1
    v_permlane16_swap_b32 v5, v52
    v_max_f32 v52, v52, v5
    v_sub_f32 v48, v48, v52
    v_sub_f32 v49, v49, v52
    v_sub_f32 v50, v50, v52
    v_sub_f32 v51, v51, v52
    v_mul_f32 v48, s42, v48
    v_mul_f32 v49, s42, v49
    v_mul_f32 v50, s42, v50
    v_mul_f32 v51, s42, v51
    v_exp_f32 v48, v48
    v_exp_f32 v49, v49
    v_exp_f32 v50, v50
    v_exp_f32 v51, v51
    v_add_f32 v48, v48, v49
    v_add_f32 v50, v50, v51
    v_add_f32 v54, v48, v50
    s_nop 1
    v_add_f32_dpp v54, v54, v54 quad_perm:[1,0,3,2] row_mask:0xf bank_mask:0xf
    s_nop 1
    v_add_f32_dpp v54, v54, v54 quad_perm:[2,3,0,1] row_mask:0xf bank_mask:0xf
    s_nop 1
    v_add_f32_dpp v54, v54, v54 row_half_mirror row_mask:0xf bank_mask:0xf
    s_nop 1
    v_add_f32_dpp v54, v54, v54 row_mirror row_mask:0xf bank_mask:0xf
    v_mov_b32 v5, v54
    s_nop 1
    v_permlane16_swap_b32 v5, v54
    v_add_f32 v54, v54, v5
    s_mov_b64 exec, s[56:57]
    s_cmp_eq_u32 s9, 1
    s_cbranch_scc1 L_ml_f
    global_store_dwordx4 v46, v[52:55], s[54:55] sc1
    s_branch L_ml_d
L_ml_f:
    global_store_dwordx4 v46, v[52:55], s[54:55]
L_ml_d:
    s_mov_b64 exec, -1
    global_load_dwordx4 v[32:35], v45, s[40:41] offset:0 sc1
    global_load_dwordx4 v[36:39], v45, s[40:41] offset:2048 sc1
    global_load_dwordx2 v[40:41], v30, s[40:41] sc1
    global_load_dwordx2 v[42:43], v30, s[40:41] offset:512 sc1
    global_load_dwordx4 v[96:99], v14, s[40:41] sc1
    s_barrier
    s_mov_b32 s10, 1048576
    s_waitcnt vmcnt(6)
L_T_chk:
    v_xor_b32 v5, s14, v44
    v_cmp_lt_u32 vcc, 1, v5
    s_cbranch_vccnz L_T_poll
L_T_got:
    s_barrier
    s_waitcnt vmcnt(0)
    v_xor_b32 v5, s14, v33
    v_bitop3_b32 v5, v35, s14, v5 bitop3:0xbe
    v_bitop3_b32 v5, v37, s14, v5 bitop3:0xbe
    v_bitop3_b32 v5, v39, s14, v5 bitop3:0xbe
    v_cmp_ne_u32 vcc, 0, v5
    s_cbranch_vccz L_ML_got
L_ML_poll:
    global_load_dwordx4 v[32:35], v45, s[40:41] offset:0 sc1
    global_load_dwordx4 v[36:39], v45, s[40:41] offset:2048 sc1
    s_waitcnt vmcnt(0)
    v_xor_b32 v5, s14, v33
    v_bitop3_b32 v5, v35, s14, v5 bitop3:0xbe
    v_bitop3_b32 v5, v37, s14, v5 bitop3:0xbe
    v_bitop3_b32 v5, v39, s14, v5 bitop3:0xbe
    v_cmp_ne_u32 vcc, 0, v5
    s_cbranch_vccz L_ML_got
    s_sub_u32 s10, s10, 1
    s_cbranch_scc0 L_ML_poll
L_ML_got:
    global_load_dwordx4 v[56:59], v13, s[40:41] sc1
    global_load_dwordx4 v[60:63], v13, s[40:41] offset:1024 sc1
    v_max_f32 v20, v32, v36
    s_nop 1
    v_max_f32_dpp v20, v20, v20 row_ror:8 row_mask:0xf bank_mask:0xf
    s_nop 1
    v_max_f32_dpp v20, v20, v20 row_ror:4 row_mask:0xf bank_mask:0xf
    v_mov_b32 v5, v20
    s_nop 1
    v_permlane16_swap_b32 v5, v20
    v_max_f32 v20, v20, v5
    v_mov_b32 v5, v20
    s_nop 1
    v_permlane32_swap_b32 v5, v20
    v_max_f32 v20, v20, v5
    v_sub_f32 v32, v32, v20
    v_sub_f32 v36, v36, v20
    v_mul_f32 v32, s42, v32
    v_mul_f32 v36, s42, v36
    v_exp_f32 v32, v32
    v_exp_f32 v36, v36
    v_mul_f32 v21, v32, v34
    v_fmac_f32 v21, v36, v38
    s_nop 1
    v_add_f32_dpp v21, v21, v21 row_ror:8 row_mask:0xf bank_mask:0xf
    s_nop 1
    v_add_f32_dpp v21, v21, v21 row_ror:4 row_mask:0xf bank_mask:0xf
    v_mov_b32 v5, v21
    s_nop 1
    v_permlane16_swap_b32 v5, v21
    v_add_f32 v21, v21, v5
    v_mov_b32 v5, v21
    s_nop 1
    v_permlane32_swap_b32 v5, v21
    v_add_f32 v21, v21, v5
    v_rcp_f32 v21, v21
    s_nop 0
    v_mul_f32 v32, v32, v21
    v_mul_f32 v36, v36, v21
    s_mov_b32 s10, 1048576
L_O_poll:
    global_load_dwordx4 v[72:75], v13, s[40:41] sc1
    global_load_dwordx4 v[76:79], v13, s[40:41] offset:1024 sc1
    s_waitcnt vmcnt(2)
    v_max3_u32 v5, v56, v57, v58
    v_max3_u32 v6, v59, v60, v61
    v_max3_u32 v5, v5, v62, v63
    v_max_u32 v5, v5, v6
    v_cmp_le_u32 vcc, -2, v5
    v_pk_mul_f32 v[48:49], v[56:57], v[32:33] op_sel_hi:[1,0]
    v_pk_mul_f32 v[50:51], v[58:59], v[32:33] op_sel_hi:[1,0]
    v_pk_fma_f32 v[48:49], v[60:61], v[36:37], v[48:49] op_sel_hi:[1,0,1]
    v_pk_fma_f32 v[50:51], v[62:63], v[36:37], v[50:51] op_sel_hi:[1,0,1]
    s_cbranch_vccz L_O_got
    global_load_dwordx4 v[56:59], v13, s[40:41] sc1
    global_load_dwordx4 v[60:63], v13, s[40:41] offset:1024 sc1
    s_waitcnt vmcnt(2)
    v_max3_u32 v5, v72, v73, v74
    v_max3_u32 v6, v75, v76, v77
    v_max3_u32 v5, v5, v78, v79
    v_max_u32 v5, v5, v6
    v_cmp_le_u32 vcc, -2, v5
    v_pk_mul_f32 v[48:49], v[72:73], v[32:33] op_sel_hi:[1,0]
    v_pk_mul_f32 v[50:51], v[74:75], v[32:33] op_sel_hi:[1,0]
    v_pk_fma_f32 v[48:49], v[76:77], v[36:37], v[48:49] op_sel_hi:[1,0,1]
    v_pk_fma_f32 v[50:51], v[78:79], v[36:37], v[50:51] op_sel_hi:[1,0,1]
    s_cbranch_vccz L_O_got
    s_sub_u32 s10, s10, 1
    s_cbranch_scc0 L_O_poll
L_O_got:
    s_nop 0
    v_permlane32_swap_b32 v48, v50
    v_permlane32_swap_b32 v49, v51
    v_pk_add_f32 v[48:49], v[48:49], v[50:51]
    s_nop 1
    v_permlane16_swap_b32 v48, v49
    v_add_f32 v48, v48, v49
    s_nop 1
    v_add_f32_dpp v48, v48, v48 row_ror:8 row_mask:0xf bank_mask:0xf
    s_nop 1
    v_add_f32_dpp v48, v48, v48 row_ror:4 row_mask:0xf bank_mask:0xf
    v_cvt_pk_bf16_f32 v48, v48, v48
    ds_write_b16 v47, v48 offset:8192
    ds_write_b16 v47, v48 offset:8210
    s_waitcnt lgkmcnt(0)
    s_barrier
    s_cmp_ge_u32 s8, 28
    s_cbranch_scc1 L_fin
    v_lshlrev_b32 v31, 16, v31
    v_mov_b32 v49, s14
    s_lshl_b32 s12, s3, 11
    s_add_u32 s12, s12, 1179648
    v_add_u32 v3, s12, v1
    s_mul_i32 s11, s3, 28
    s_add_u32 s11, s11, s8
    s_lshl_b32 s11, s11, 3
    s_add_u32 s12, s12, s11
    v_mov_b32 v4, s12
    s_mov_b32 s43, 0xffff0000
    s_mov_b32 s48, 991054117
    s_mov_b32 s49, 1065353300
    v_mov_b32 v2, 786163455
    s_mov_b32 s34, 0
    s_mov_b32 s35, 0x80000000
    s_mov_b32 s50, -1
    s_mov_b32 s51, 0xffff
    s_mov_b32 s10, 1048576
    s_branch L_SD_chk
L_SD_poll:
    s_sub_u32 s10, s10, 1
    s_cbranch_scc1 L_SD_got
    global_load_dwordx2 v[40:41], v30, s[40:41] sc1
    global_load_dwordx2 v[42:43], v30, s[40:41] offset:512 sc1
L_SD_chk:
    s_waitcnt vmcnt(0)
    v_xor_b32 v5, s14, v41
    v_bitop3_b32 v5, v43, s14, v5 bitop3:0xbe
    v_cmp_ne_u32 vcc, 0, v5
    s_cbranch_vccnz L_SD_poll
L_SD_got:
    v_add_u32 v5, v40, v42
    v_and_b32 v5, 0xff, v5
    s_nop 1
    v_add_u32_dpp v5, v5, v5 row_ror:8 row_mask:0xf bank_mask:0xf
    s_nop 1
    v_add_u32_dpp v5, v5, v5 row_ror:4 row_mask:0xf bank_mask:0xf
    s_and_b32 s12, s3, 3
    s_lshl_b32 s12, s12, 2
    v_cmp_lt_u32 vcc, 32, v5
    s_nop 1
    v_cndmask_b32 v5, 0, -1, vcc
    v_xor_b32 v40, v40, v5
    v_xor_b32 v42, v42, v5
    v_and_b32 v40, 0x2000, v40
    v_and_b32 v42, 0x2000, v42
    v_add_u32 v26, v26, v40
    v_add_u32 v27, v27, v42
    v_readlane_b32 s38, v40, s12
    v_readlane_b32 s39, v42, s12
    s_cmp_lt_u32 s3, 4
    s_cselect_b32 s38, s38, s39
    v_add_u32 v28, s38, v28
    s_waitcnt vmcnt(0)
    v_mov_b32 v116, 0
    v_mov_b32 v117, s14
    v_mov_b32 v118, 0
    v_mov_b32 v119, s14
    v_mov_b32 v12, 0
    v_mov_b32 v13, s14
    v_mov_b32 v14, 0
    v_mov_b32 v15, s14
    v_mov_b32 v58, 0
    v_mov_b32 v59, s14
    v_mov_b32 v60, 0
    v_mov_b32 v61, s14
    global_load_dwordx4 v[64:67], v24, s[40:41] sc1
    global_load_dwordx4 v[68:71], v25, s[40:41] sc1
    global_load_dwordx4 v[72:75], v24, s[40:41] sc1
    global_load_dwordx4 v[76:79], v25, s[40:41] sc1
    s_mov_b32 s10, 1048576
L_RS_poll:
    global_load_dwordx4 v[80:83], v24, s[40:41] sc1
    global_load_dwordx4 v[84:87], v25, s[40:41] sc1
    s_waitcnt vmcnt(4)
    v_bitop3_b32 v5, v64, v65, v66 bitop3:0x80
    v_bitop3_b32 v6, v67, v68, v69 bitop3:0x80
    v_bitop3_b32 v5, v5, v70, v71 bitop3:0x80
    v_bitop3_b32 v5, v5, v6, 1 bitop3:0x80
    v_cmp_eq_u32 vcc, 0, v5
    v_pk_add_f32 v[52:53], v[64:65], v[68:69]
    v_pk_add_f32 v[54:55], v[66:67], v[70:71]
    s_cbranch_vccz L_RS_got
    global_load_dwordx4 v[64:67], v24, s[40:41] sc1
    global_load_dwordx4 v[68:71], v25, s[40:41] sc1
    s_waitcnt vmcnt(4)
    v_bitop3_b32 v5, v72, v73, v74 bitop3:0x80
    v_bitop3_b32 v6, v75, v76, v77 bitop3:0x80
    v_bitop3_b32 v5, v5, v78, v79 bitop3:0x80
    v_bitop3_b32 v5, v5, v6, 1 bitop3:0x80
    v_cmp_eq_u32 vcc, 0, v5
    v_pk_add_f32 v[52:53], v[72:73], v[76:77]
    v_pk_add_f32 v[54:55], v[74:75], v[78:79]
    s_cbranch_vccz L_RS_got
    global_load_dwordx4 v[72:75], v24, s[40:41] sc1
    global_load_dwordx4 v[76:79], v25, s[40:41] sc1
    s_waitcnt vmcnt(4)
    v_bitop3_b32 v5, v80, v81, v82 bitop3:0x80
    v_bitop3_b32 v6, v83, v84, v85 bitop3:0x80
    v_bitop3_b32 v5, v5, v86, v87 bitop3:0x80
    v_bitop3_b32 v5, v5, v6, 1 bitop3:0x80
    v_cmp_eq_u32 vcc, 0, v5
    v_pk_add_f32 v[52:53], v[80:81], v[84:85]
    v_pk_add_f32 v[54:55], v[82:83], v[86:87]
    s_cbranch_vccz L_RS_got
    s_sub_u32 s10, s10, 1
    s_cbranch_scc0 L_RS_poll
L_RS_got:
    s_nop 0
    v_permlane32_swap_b32 v52, v54
    v_permlane32_swap_b32 v53, v55
    v_pk_add_f32 v[52:53], v[52:53], v[54:55]
    s_nop 1
    v_permlane16_swap_b32 v52, v53
    v_add_f32 v48, v52, v53
    s_nop 1
    v_add_f32_dpp v48, v48, v48 row_ror:8 row_mask:0xf bank_mask:0xf
    s_nop 1
    v_add_f32_dpp v48, v48, v48 row_ror:4 row_mask:0xf bank_mask:0xf
    global_store_dwordx2 v26, v[48:49], s[40:41] sc1
    global_store_dwordx2 v27, v[48:49], s[40:41] sc1
    global_load_dwordx4 v[96:99], v28, s[40:41] sc1
    global_load_dwordx4 v[100:103], v28, s[40:41] sc1
    global_load_dwordx4 v[104:107], v28, s[40:41] sc1
    s_mov_b32 s10, 1048576
L_I_poll:
    global_load_dwordx4 v[108:111], v28, s[40:41] sc1
    s_waitcnt vmcnt(3)
    v_xor_b32 v5, s14, v97
    v_bitop3_b32 v5, v99, s14, v5 bitop3:0xbe
    v_cmp_ne_u32 vcc, 0, v5
    v_permlane32_swap_b32 v96, v98
    v_add_f32 v52, v96, v98
    s_cbranch_vccz L_I_got
    global_load_dwordx4 v[96:99], v28, s[40:41] sc1
    s_waitcnt vmcnt(3)
    v_xor_b32 v5, s14, v101
    v_bitop3_b32 v5, v103, s14, v5 bitop3:0xbe
    v_cmp_ne_u32 vcc, 0, v5
    v_permlane32_swap_b32 v100, v102
    v_add_f32 v52, v100, v102
    s_cbranch_vccz L_I_got
    global_load_dwordx4 v[100:103], v28, s[40:41] sc1
    s_waitcnt vmcnt(3)
    v_xor_b32 v5, s14, v105
    v_bitop3_b32 v5, v107, s14, v5 bitop3:0xbe
    v_cmp_ne_u32 vcc, 0, v5
    v_permlane32_swap_b32 v104, v106
    v_add_f32 v52, v104, v106
    s_cbranch_vccz L_I_got
    global_load_dwordx4 v[104:107], v28, s[40:41] sc1
    s_waitcnt vmcnt(3)
    v_xor_b32 v5, s14, v109
    v_bitop3_b32 v5, v111, s14, v5 bitop3:0xbe
    v_cmp_ne_u32 vcc, 0, v5
    v_permlane32_swap_b32 v108, v110
    v_add_f32 v52, v108, v110
    s_cbranch_vccz L_I_got
    s_sub_u32 s10, s10, 1
    s_cbranch_scc0 L_I_poll
L_I_got:
    s_nop 0
    v_add_f32_dpp v52, v52, v52 row_ror:8 row_mask:0xf bank_mask:0xf
    v_mov_b32 v54, v52
    s_nop 1
    v_permlane16_swap_b32 v54, v52
    v_add_f32 v52, v52, v54
    v_cvt_pk_bf16_f32 v52, v52, v52
    v_lshlrev_b32 v52, 16, v52
    v_add_f32 v52, v52, v31
    v_mov_b32 v54, v52
    s_nop 1
    v_permlane32_swap_b32 v54, v52
    v_cvt_pk_bf16_f32 v48, v54, v52
    s_mov_b64 exec, s[44:45]
    global_store_dwordx2 v29, v[48:49], s[40:41]
    s_mov_b64 exec, s[46:47]
    global_store_dwordx2 v29, v[48:49], s[40:41] sc1
    s_mov_b64 exec, -1
    s_branch L_HH
L_S:
    s_mov_b32 s8, s4
    s_cmp_ge_u32 s8, 28
    s_cbranch_scc1 L_S_1
    s_cmp_ge_u32 s5, 4
    s_cbranch_scc1 L_S_1
    s_lshl_b32 s12, s5, 6
    v_add_u32 v12, s12, v0
    v_mul_u32_u24 v13, 14, v12
    v_and_b32 v14, 1, v0
    v_lshlrev_b32 v14, 1, v14
    v_sub_u32 v13, v13, v14
    global_load_dwordx4 v[112:115], v13, s[28:29]
    global_load_dwordx4 v[116:119], v13, s[30:31]
    global_load_dwordx4 v[120:123], v13, s[32:33]
    v_mov_b32 v14, 0
    global_load_ushort v125, v14, s[34:35]
L_S_1:
    v_and_b32 v4, 1, v0
    v_lshlrev_b32 v4, 4, v4
    v_mov_b32 v5, 0xffff
    v_lshlrev_b32 v4, v4, v5
    v_bfe_u32 v5, v0, 1, 2
    v_cmp_eq_u32 s[44:45], 0, v5
    v_cmp_eq_u32 s[46:47], 1, v5
    v_cmp_eq_u32 s[48:49], 2, v5
    v_cmp_eq_u32 s[50:51], 3, v5
    v_cndmask_b32 v8, 0, v4, s[44:45]
    v_cndmask_b32 v9, 0, v4, s[46:47]
    v_cndmask_b32 v10, 0, v4, s[48:49]
    v_cndmask_b32 v11, 0, v4, s[50:51]
    v_bfe_u32 v3, v0, 3, 1
    v_lshl_add_u32 v6, v3, 9, v6
    v_lshrrev_b32 v4, 4, v0
    s_lshl_b32 s12, s5, 2
    v_add_u32 v7, s12, v4
    v_lshlrev_b32 v7, 4, v7
    v_lshl_add_u32 v7, v3, 9, v7
    v_lshlrev_b32 v4, 3, v4
    v_and_b32 v5, 7, v0
    v_add_u32 v4, v4, v5
    v_lshlrev_b32 v4, 4, v4
    v_lshl_add_u32 v3, v3, 9, v4
    s_mov_b32 s42, 1035512379
    s_mov_b32 s44, 0x01010101
    s_mov_b32 s45, 0x01010101
    v_mov_b32 v5, 0
    s_waitcnt lgkmcnt(0)
    s_barrier
    s_barrier
    global_load_dwordx4 v[56:59], v1, s[52:53] offset:2048 nt
    global_load_dwordx4 v[60:63], v1, s[52:53] offset:2304 nt
    s_cmp_eq_u32 s5, 7
    s_cbranch_scc1 L_S_k
    global_load_dwordx4 v[64:67], v2, s[54:55] offset:-4096 nt
    global_load_dwordx4 v[68:71], v2, s[54:55] offset:-3840 nt
L_S_k:
    s_barrier
    s_barrier
    s_cmp_eq_u32 s5, 7
    s_cbranch_scc1 L_S_k3
    global_load_dwordx4 v[72:75], v2, s[54:55] offset:-2048 nt
    global_load_dwordx4 v[76:79], v2, s[54:55] offset:-1792 nt
    global_load_dwordx4 v[80:83], v2, s[54:55] offset:0 nt
L_S_k3:
    s_barrier
    s_barrier
    s_cmp_eq_u32 s5, 7
    s_cbranch_scc1 L_S_q
    global_load_dwordx4 v[84:87], v2, s[54:55] offset:256 nt
    global_load_dwordx4 v[88:91], v2, s[54:55] offset:2048 nt
    global_load_dwordx4 v[92:95], v2, s[54:55] offset:2304 nt
L_S_q:
    s_barrier
    ds_read_b128 v[12:15], v6 offset:4096
    ds_read_b128 v[16:19], v6 offset:4352
    ds_read_b96 v[20:22], v5 offset:6144
    s_cmp_lg_u32 s5, 7
    s_cbranch_scc1 L_S_qk
    global_load_dwordx4 v[64:67], v2, s[54:55] offset:-4096 nt
    global_load_dwordx4 v[68:71], v2, s[54:55] offset:-3840 nt
    global_load_dwordx4 v[72:75], v2, s[54:55] offset:-2048 nt
    global_load_dwordx4 v[76:79], v2, s[54:55] offset:-1792 nt
    global_load_dwordx4 v[80:83], v2, s[54:55] offset:0 nt
    global_load_dwordx4 v[84:87], v2, s[54:55] offset:256 nt
    global_load_dwordx4 v[88:91], v2, s[54:55] offset:2048 nt
    global_load_dwordx4 v[92:95], v2, s[54:55] offset:2304 nt
    s_waitcnt vmcnt(8)
L_S_qk:
    s_waitcnt vmcnt(8) lgkmcnt(0)
    v_mfma_f32_16x16x32_bf16 v[96:99], v[32:35], v[12:15], 0
    v_mfma_f32_16x16x32_bf16 v[96:99], v[36:39], v[16:19], v[96:99]
    v_mfma_f32_16x16x32_bf16 v[100:103], v[40:43], v[12:15], 0
    v_mfma_f32_16x16x32_bf16 v[100:103], v[44:47], v[16:19], v[100:103]
    v_readfirstlane_b32 s9, v20
    v_readfirstlane_b32 s14, v21
    v_readfirstlane_b32 s13, v22
    v_mfma_f32_16x16x32_bf16 v[104:107], v[48:51], v[12:15], 0
    v_mfma_f32_16x16x32_bf16 v[104:107], v[52:55], v[16:19], v[104:107]
    s_nop 0
    v_mov_b32_dpp v28, v96 quad_perm:[0,0,0,0] row_mask:0xf bank_mask:0xf
    v_mfma_f32_16x16x32_bf16 v[108:111], v[56:59], v[12:15], 0
    v_mov_b32_dpp v29, v100 quad_perm:[0,0,0,0] row_mask:0xf bank_mask:0xf
    v_add_f32_dpp v28, v97, v28 quad_perm:[1,1,1,1] row_mask:0xf bank_mask:0xf
    v_mfma_f32_16x16x32_bf16 v[108:111], v[60:63], v[16:19], v[108:111]
    v_add_f32_dpp v29, v101, v29 quad_perm:[1,1,1,1] row_mask:0xf bank_mask:0xf
    v_add_f32_dpp v28, v98, v28 quad_perm:[2,2,2,2] row_mask:0xf bank_mask:0xf
    v_mov_b32_dpp v30, v104 quad_perm:[0,0,0,0] row_mask:0xf bank_mask:0xf
    v_add_f32_dpp v29, v102, v29 quad_perm:[2,2,2,2] row_mask:0xf bank_mask:0xf
    v_add_f32_dpp v28, v99, v28 quad_perm:[3,3,3,3] row_mask:0xf bank_mask:0xf
    v_add_f32_dpp v30, v105, v30 quad_perm:[1,1,1,1] row_mask:0xf bank_mask:0xf
    v_add_f32_dpp v29, v103, v29 quad_perm:[3,3,3,3] row_mask:0xf bank_mask:0xf
    v_cvt_pk_bf16_f32 v28, v28, v28
    v_add_f32_dpp v30, v106, v30 quad_perm:[2,2,2,2] row_mask:0xf bank_mask:0xf
    v_mov_b32_dpp v31, v108 quad_perm:[0,0,0,0] row_mask:0xf bank_mask:0xf
    v_cvt_pk_bf16_f32 v29, v29, v29
    v_add_f32_dpp v30, v107, v30 quad_perm:[3,3,3,3] row_mask:0xf bank_mask:0xf
    v_add_f32_dpp v31, v109, v31 quad_perm:[1,1,1,1] row_mask:0xf bank_mask:0xf
    v_lshlrev_b32 v28, 16, v28
    v_cvt_pk_bf16_f32 v30, v30, v30
    v_add_f32_dpp v31, v110, v31 quad_perm:[2,2,2,2] row_mask:0xf bank_mask:0xf
    v_lshlrev_b32 v29, 16, v29
    v_lshlrev_b32 v30, 16, v30
    v_add_f32_dpp v31, v111, v31 quad_perm:[3,3,3,3] row_mask:0xf bank_mask:0xf
    v_cvt_pk_bf16_f32 v31, v31, v31
    v_lshlrev_b32 v31, 16, v31
    s_mov_b64 exec, s[44:45]
    ds_write_b128 v7, v[28:31] offset:5120
    s_mov_b64 exec, -1
    s_waitcnt lgkmcnt(0)
    s_barrier
    ds_read_b128 v[12:15], v3 offset:5120
    s_waitcnt lgkmcnt(0)
    v_max3_f32 v4, v12, v13, v14
    v_max_f32 v4, v4, v15
    s_nop 1
    v_max_f32_dpp v4, v4, v4 quad_perm:[1,0,3,2] row_mask:0xf bank_mask:0xf
    s_nop 1
    v_max_f32_dpp v4, v4, v4 quad_perm:[2,3,0,1] row_mask:0xf bank_mask:0xf
    s_nop 1
    v_max_f32_dpp v4, v4, v4 row_half_mirror row_mask:0xf bank_mask:0xf
    v_mov_b32 v5, v4
    s_nop 1
    v_permlane16_swap_b32 v5, v4
    v_max_f32 v4, v4, v5
    v_mov_b32 v5, v4
    s_nop 1
    v_permlane32_swap_b32 v5, v4
    v_max_f32 v4, v4, v5
    v_sub_f32 v28, v28, v4
    v_sub_f32 v29, v29, v4
    v_sub_f32 v30, v30, v4
    v_sub_f32 v31, v31, v4
    v_mul_f32 v28, s42, v28
    v_mul_f32 v29, s42, v29
    v_mul_f32 v30, s42, v30
    v_mul_f32 v31, s42, v31
    v_exp_f32 v28, v28
    v_exp_f32 v29, v29
    v_exp_f32 v30, v30
    v_exp_f32 v31, v31
    v_cvt_pk_bf16_f32 v28, v28, v28
    v_cvt_pk_bf16_f32 v29, v29, v29
    v_cvt_pk_bf16_f32 v30, v30, v30
    v_cvt_pk_bf16_f32 v31, v31, v31
    v_and_b32 v96, v28, v8
    v_and_b32 v97, v28, v9
    v_and_b32 v98, v28, v10
    v_and_b32 v99, v28, v11
    v_and_b32 v100, v29, v8
    v_and_b32 v101, v29, v9
    v_and_b32 v102, v29, v10
    v_and_b32 v103, v29, v11
    v_and_b32 v104, v30, v8
    v_and_b32 v105, v30, v9
    v_and_b32 v106, v30, v10
    v_and_b32 v107, v30, v11
    v_and_b32 v108, v31, v8
    v_and_b32 v109, v31, v9
    v_and_b32 v110, v31, v10
    v_and_b32 v111, v31, v11
    v_lshlrev_b32 v1, 4, v0
    s_barrier
    s_cmp_eq_u32 s5, 7
    s_cbranch_scc1 L_F
    s_waitcnt vmcnt(7)
    v_mfma_f32_16x16x32_bf16 v[20:23], v[96:99], v[64:67], 0
    s_waitcnt vmcnt(6)
    v_mfma_f32_16x16x32_bf16 v[24:27], v[96:99], v[68:71], 0
    s_waitcnt vmcnt(5)
    v_mfma_f32_16x16x32_bf16 v[20:23], v[100:103], v[72:75], v[20:23]
    s_waitcnt vmcnt(4)
    v_mfma_f32_16x16x32_bf16 v[24:27], v[100:103], v[76:79], v[24:27]
    s_waitcnt vmcnt(3)
    v_mfma_f32_16x16x32_bf16 v[20:23], v[104:107], v[80:83], v[20:23]
    s_waitcnt vmcnt(2)
    v_mfma_f32_16x16x32_bf16 v[24:27], v[104:107], v[84:87], v[24:27]
    s_waitcnt vmcnt(1)
    v_mfma_f32_16x16x32_bf16 v[20:23], v[108:111], v[88:91], v[20:23]
    s_waitcnt vmcnt(0)
    v_mfma_f32_16x16x32_bf16 v[24:27], v[108:111], v[92:95], v[24:27]
    s_lshl_b32 s12, s5, 11
    v_add_u32 v2, s12, v1
    s_nop 3
    ds_write_b128 v2, v[20:23] offset:10240
    s_nop 0
    ds_write_b128 v2, v[24:27] offset:11264
    s_waitcnt lgkmcnt(0)
    s_cmp_ge_u32 s8, 28
    s_cbranch_scc1 L_S_x
    s_cmp_lt_u32 s5, 4
    s_cbranch_scc1 L_M
L_S_x:
    s_barrier
    s_endpgm
L_M:
    s_lshl_b32 s12, s3, 11
    s_add_u32 s12, s12, 1179648
    v_add_u32 v3, s12, v1
    s_mov_b32 s50, -1
    s_mov_b32 s51, 0xffff
    s_cmp_lg_u32 s5, 0
    s_cbranch_scc1 L_M_1
    global_load_dwordx4 v[96:99], v3, s[40:41] sc1
    s_mov_b64 exec, s[50:51]
    global_load_dwordx4 v[100:103], v3, s[40:41] offset:1024 sc1
    s_mov_b64 exec, -1
L_M_1:
    s_barrier
    s_mov_b32 s43, 0xffff0000
    v_and_b32 v5, 1, v0
    v_lshlrev_b32 v5, 4, v5
    v_mov_b32 v88, 3222493025
    v_mov_b32 v89, 3184710632
    v_mov_b32 v90, 1.0
    s_mul_i32 s11, s3, 28
    s_add_u32 s11, s11, s8
    s_lshl_b32 s11, s11, 1
    s_lshl_b32 s15, s11, 2
    s_add_u32 s12, s12, s15
    v_mov_b32 v4, s12
    s_mov_b32 s48, 991054117
    s_mov_b32 s49, 925353388
    s_waitcnt vmcnt(0)
    v_alignbit_b32 v112, v113, v112, v5
    v_alignbit_b32 v113, v114, v113, v5
    v_alignbit_b32 v114, v115, v114, v5
    v_lshrrev_b32 v115, v5, v115
    v_lshlrev_b32 v64, 16, v112
    v_and_b32 v65, s43, v112
    v_lshlrev_b32 v66, 16, v113
    v_and_b32 v67, s43, v113
    v_lshlrev_b32 v68, 16, v114
    v_and_b32 v69, s43, v114
    v_lshlrev_b32 v70, 16, v115
    v_alignbit_b32 v116, v117, v116, v5
    v_alignbit_b32 v117, v118, v117, v5
    v_alignbit_b32 v118, v119, v118, v5
    v_lshrrev_b32 v119, v5, v119
    v_lshlrev_b32 v72, 16, v116
    v_and_b32 v73, s43, v116
    v_lshlrev_b32 v74, 16, v117
    v_and_b32 v75, s43, v117
    v_lshlrev_b32 v76, 16, v118
    v_and_b32 v77, s43, v118
    v_lshlrev_b32 v78, 16, v119
    v_alignbit_b32 v120, v121, v120, v5
    v_alignbit_b32 v121, v122, v121, v5
    v_alignbit_b32 v122, v123, v122, v5
    v_lshrrev_b32 v123, v5, v123
    v_lshlrev_b32 v80, 16, v120
    v_and_b32 v81, s43, v120
    v_lshlrev_b32 v82, 16, v121
    v_and_b32 v83, s43, v121
    v_lshlrev_b32 v84, 16, v122
    v_and_b32 v85, s43, v122
    v_lshlrev_b32 v86, 16, v123
    v_lshlrev_b32 v125, 16, v125
    v_lshrrev_b32 v6, 5, v0
    v_lshlrev_b32 v6, 4, v6
    s_lshl_b32 s12, s5, 2
    v_add_u32 v6, s12, v6
    s_lshl_b32 s12, s11, 1
    v_lshl_add_u32 v7, v0, 1, s12
    s_mov_b32 s46, 0x10000
    s_mov_b32 s47, 0x10000
    s_cmp_eq_u32 s5, 0
    s_cselect_b64 s[44:45], 3, 0
    v_mov_b32 v5, 0
    s_barrier
    s_barrier
    ds_read_b128 v[92:95], v5 offset:6656
    s_waitcnt lgkmcnt(0)
    v_pk_fma_f32 v[32:33], v[92:93], v[64:65], v[72:73] op_sel:[0,0,0] op_sel_hi:[1,0,0]
    v_pk_fma_f32 v[34:35], v[92:93], v[64:65], v[72:73] op_sel:[0,1,1] op_sel_hi:[1,1,1]
    v_pk_fma_f32 v[36:37], v[92:93], v[66:67], v[74:75] op_sel:[0,0,0] op_sel_hi:[1,0,0]
    v_pk_fma_f32 v[38:39], v[92:93], v[66:67], v[74:75] op_sel:[0,1,1] op_sel_hi:[1,1,1]
    v_pk_fma_f32 v[40:41], v[92:93], v[68:69], v[76:77] op_sel:[0,0,0] op_sel_hi:[1,0,0]
    v_pk_fma_f32 v[42:43], v[92:93], v[68:69], v[76:77] op_sel:[0,1,1] op_sel_hi:[1,1,1]
    v_pk_fma_f32 v[44:45], v[92:93], v[70:71], v[78:79] op_sel:[0,0,0] op_sel_hi:[1,0,0]
    v_pk_mul_f32 v[48:49], v[32:33], v[32:33]
    v_pk_mul_f32 v[50:51], v[34:35], v[34:35]
    v_pk_mul_f32 v[52:53], v[36:37], v[36:37]
    v_pk_mul_f32 v[54:55], v[38:39], v[38:39]
    v_pk_mul_f32 v[56:57], v[40:41], v[40:41]
    v_pk_mul_f32 v[58:59], v[42:43], v[42:43]
    v_pk_mul_f32 v[60:61], v[44:45], v[44:45]
    v_pk_fma_f32 v[48:49], v[48:49], v[88:89], v[88:89] op_sel:[0,1,0] op_sel_hi:[1,1,0]
    v_pk_fma_f32 v[50:51], v[50:51], v[88:89], v[88:89] op_sel:[0,1,0] op_sel_hi:[1,1,0]
    v_pk_fma_f32 v[52:53], v[52:53], v[88:89], v[88:89] op_sel:[0,1,0] op_sel_hi:[1,1,0]
    v_pk_fma_f32 v[54:55], v[54:55], v[88:89], v[88:89] op_sel:[0,1,0] op_sel_hi:[1,1,0]
    v_pk_fma_f32 v[56:57], v[56:57], v[88:89], v[88:89] op_sel:[0,1,0] op_sel_hi:[1,1,0]
    v_pk_fma_f32 v[58:59], v[58:59], v[88:89], v[88:89] op_sel:[0,1,0] op_sel_hi:[1,1,0]
    v_pk_fma_f32 v[60:61], v[60:61], v[88:89], v[88:89] op_sel:[0,1,0] op_sel_hi:[1,1,0]
    v_pk_mul_f32 v[48:49], v[48:49], v[32:33]
    v_pk_mul_f32 v[50:51], v[50:51], v[34:35]
    v_pk_mul_f32 v[52:53], v[52:53], v[36:37]
    v_pk_mul_f32 v[54:55], v[54:55], v[38:39]
    v_pk_mul_f32 v[56:57], v[56:57], v[40:41]
    v_pk_mul_f32 v[58:59], v[58:59], v[42:43]
    v_pk_mul_f32 v[60:61], v[60:61], v[44:45]
    v_exp_f32 v48, v48
    v_exp_f32 v49, v49
    v_exp_f32 v50, v50
    v_exp_f32 v51, v51
    v_exp_f32 v52, v52
    v_exp_f32 v53, v53
    v_exp_f32 v54, v54
    v_exp_f32 v55, v55
    v_exp_f32 v56, v56
    v_exp_f32 v57, v57
    v_exp_f32 v58, v58
    v_exp_f32 v59, v59
    v_exp_f32 v60, v60
    v_exp_f32 v61, v61
    v_pk_mul_f32 v[32:33], v[32:33], v[80:81] op_sel:[0,0] op_sel_hi:[1,0]
    v_pk_mul_f32 v[34:35], v[34:35], v[80:81] op_sel:[0,1] op_sel_hi:[1,1]
    v_pk_mul_f32 v[36:37], v[36:37], v[82:83] op_sel:[0,0] op_sel_hi:[1,0]
    v_pk_mul_f32 v[38:39], v[38:39], v[82:83] op_sel:[0,1] op_sel_hi:[1,1]
    v_pk_mul_f32 v[40:41], v[40:41], v[84:85] op_sel:[0,0] op_sel_hi:[1,0]
    v_pk_mul_f32 v[42:43], v[42:43], v[84:85] op_sel:[0,1] op_sel_hi:[1,1]
    v_pk_mul_f32 v[44:45], v[44:45], v[86:87] op_sel:[0,0] op_sel_hi:[1,0]
    v_pk_add_f32 v[48:49], v[48:49], v[90:91] op_sel_hi:[1,0]
    v_pk_add_f32 v[50:51], v[50:51], v[90:91] op_sel_hi:[1,0]
    v_pk_add_f32 v[52:53], v[52:53], v[90:91] op_sel_hi:[1,0]
    v_pk_add_f32 v[54:55], v[54:55], v[90:91] op_sel_hi:[1,0]
    v_pk_add_f32 v[56:57], v[56:57], v[90:91] op_sel_hi:[1,0]
    v_pk_add_f32 v[58:59], v[58:59], v[90:91] op_sel_hi:[1,0]
    v_pk_add_f32 v[60:61], v[60:61], v[90:91] op_sel_hi:[1,0]
    v_rcp_f32 v48, v48
    v_rcp_f32 v49, v49
    v_rcp_f32 v50, v50
    v_rcp_f32 v51, v51
    v_rcp_f32 v52, v52
    v_rcp_f32 v53, v53
    v_rcp_f32 v54, v54
    v_rcp_f32 v55, v55
    v_rcp_f32 v56, v56
    v_rcp_f32 v57, v57
    v_rcp_f32 v58, v58
    v_rcp_f32 v59, v59
    v_rcp_f32 v60, v60
    v_rcp_f32 v61, v61
    v_pk_mul_f32 v[20:21], v[32:33], v[48:49]
    v_pk_fma_f32 v[20:21], v[34:35], v[50:51], v[20:21]
    v_pk_fma_f32 v[20:21], v[36:37], v[52:53], v[20:21]
    v_pk_fma_f32 v[20:21], v[38:39], v[54:55], v[20:21]
    v_pk_fma_f32 v[20:21], v[40:41], v[56:57], v[20:21]
    v_pk_fma_f32 v[20:21], v[42:43], v[58:59], v[20:21]
    v_pk_fma_f32 v[20:21], v[44:45], v[60:61], v[20:21]
    s_nop 1
    v_permlane32_swap_b32 v20, v21
    v_add_f32 v20, v20, v21
    s_nop 1
    v_add_f32_dpp v20, v20, v20 quad_perm:[1,0,3,2] row_mask:0xf bank_mask:0xf
    s_nop 1
    v_add_f32_dpp v20, v20, v20 quad_perm:[2,3,0,1] row_mask:0xf bank_mask:0xf
    s_nop 1
    v_add_f32_dpp v20, v20, v20 row_half_mirror row_mask:0xf bank_mask:0xf
    s_nop 1
    v_add_f32_dpp v20, v20, v20 row_mirror row_mask:0xf bank_mask:0xf
    s_nop 1
    v_add_f32_dpp v20, v20, v20 row_bcast:15 row_mask:0xa bank_mask:0xf
    s_mov_b64 exec, s[46:47]
    ds_write_b32 v6, v20 offset:6912
    s_mov_b64 exec, 2
    v_mov_b32 v94, v95
    s_mov_b64 exec, 3
    s_waitcnt lgkmcnt(0)
    s_barrier
    ds_read_b128 v[20:23], v1 offset:6912
    s_waitcnt lgkmcnt(0)
    v_pk_add_f32 v[20:21], v[20:21], v[22:23]
    v_add_f32 v20, v20, v21
    v_cvt_pk_bf16_f32 v20, v20, v20
    v_lshlrev_b32 v20, 16, v20
    v_add_f32 v20, v20, v125
    v_cvt_pk_bf16_f32 v20, v20, v20
    v_lshlrev_b32 v20, 16, v20
    v_add_f32 v20, v20, v94
    s_mov_b64 exec, s[44:45]
    v_cvt_pk_bf16_f32 v20, v20, v20
    global_store_short v7, v20, s[36:37]
    s_or_b32 s12, s2, s5
    s_cbranch_scc1 L_fin
    s_add_u32 s13, s13, 16
    v_mov_b32 v4, s13
    v_mov_b32 v5, 0
    s_mov_b64 exec, 1
    global_store_dword v5, v4, s[40:41] offset:0
L_fin:
    s_endpgm
L_HH:
    global_load_dwordx2 v[120:121], v4, s[40:41] sc1
    global_load_dwordx4 v[112:115], v3, s[40:41] sc1
    s_mov_b64 exec, s[50:51]
    global_load_dwordx4 v[116:119], v3, s[40:41] offset:1024 sc1
    s_mov_b64 exec, -1
    s_mov_b32 s10, 1048576
L_A_poll:
    global_load_dwordx2 v[16:17], v4, s[40:41] sc1
    global_load_dwordx4 v[8:11], v3, s[40:41] sc1
    s_mov_b64 exec, s[50:51]
    global_load_dwordx4 v[12:15], v3, s[40:41] offset:1024 sc1
    s_mov_b64 exec, -1
    s_waitcnt vmcnt(3)
    v_xor_b32 v5, s14, v113
    v_bitop3_b32 v5, v115, s14, v5 bitop3:0xbe
    v_bitop3_b32 v5, v117, s14, v5 bitop3:0xbe
    v_bitop3_b32 v5, v119, s14, v5 bitop3:0xbe
    v_bitop3_b32 v5, v121, s14, v5 bitop3:0xbe
    v_cmp_ne_u32 vcc, 0, v5
    v_and_b32 v95, s43, v120
    v_lshlrev_b32 v94, 16, v120
    v_and_b32 v33, s43, v112
    v_lshlrev_b32 v32, 16, v112
    v_and_b32 v35, s43, v114
    v_lshlrev_b32 v34, 16, v114
    v_and_b32 v41, s43, v116
    v_lshlrev_b32 v40, 16, v116
    v_and_b32 v47, s43, v118
    v_lshlrev_b32 v46, 16, v118
    s_cbranch_vccz L_A_got
    global_load_dwordx2 v[120:121], v4, s[40:41] sc1
    global_load_dwordx4 v[112:115], v3, s[40:41] sc1
    s_mov_b64 exec, s[50:51]
    global_load_dwordx4 v[116:119], v3, s[40:41] offset:1024 sc1
    s_mov_b64 exec, -1
    s_waitcnt vmcnt(3)
    v_xor_b32 v5, s14, v9
    v_bitop3_b32 v5, v11, s14, v5 bitop3:0xbe
    v_bitop3_b32 v5, v13, s14, v5 bitop3:0xbe
    v_bitop3_b32 v5, v15, s14, v5 bitop3:0xbe
    v_bitop3_b32 v5, v17, s14, v5 bitop3:0xbe
    v_cmp_ne_u32 vcc, 0, v5
    v_and_b32 v95, s43, v16
    v_lshlrev_b32 v94, 16, v16
    v_and_b32 v33, s43, v8
    v_lshlrev_b32 v32, 16, v8
    v_and_b32 v35, s43, v10
    v_lshlrev_b32 v34, 16, v10
    v_and_b32 v41, s43, v12
    v_lshlrev_b32 v40, 16, v12
    v_and_b32 v47, s43, v14
    v_lshlrev_b32 v46, 16, v14
    s_cbranch_vccz L_A_got
    s_sub_u32 s10, s10, 1
    s_cbranch_scc0 L_A_poll
L_A_got:
    v_pk_mul_f32 v[42:43], v[32:33], v[32:33]
    v_pk_add_f32 v[44:45], v[32:33], v[34:35]
    v_pk_fma_f32 v[42:43], v[34:35], v[34:35], v[42:43]
    v_pk_add_f32 v[44:45], v[44:45], v[40:41]
    v_pk_fma_f32 v[42:43], v[40:41], v[40:41], v[42:43]
    v_pk_add_f32 v[44:45], v[44:45], v[46:47]
    v_pk_fma_f32 v[42:43], v[46:47], v[46:47], v[42:43]
    v_add_f32 v44, v44, v45
    v_add_f32 v42, v42, v43
    s_nop 0
    v_add_f32_dpp v44, v44, v44 quad_perm:[1,0,3,2] row_mask:0xf bank_mask:0xf
    v_add_f32_dpp v42, v42, v42 quad_perm:[1,0,3,2] row_mask:0xf bank_mask:0xf
    s_nop 0
    v_add_f32_dpp v44, v44, v44 quad_perm:[2,3,0,1] row_mask:0xf bank_mask:0xf
    v_add_f32_dpp v42, v42, v42 quad_perm:[2,3,0,1] row_mask:0xf bank_mask:0xf
    s_nop 0
    v_add_f32_dpp v44, v44, v44 row_half_mirror row_mask:0xf bank_mask:0xf
    v_add_f32_dpp v42, v42, v42 row_half_mirror row_mask:0xf bank_mask:0xf
    s_nop 0
    v_add_f32_dpp v44, v44, v44 row_mirror row_mask:0xf bank_mask:0xf
    v_add_f32_dpp v42, v42, v42 row_mirror row_mask:0xf bank_mask:0xf
    s_nop 0
    v_add_f32_dpp v44, v44, v44 row_bcast:15 row_mask:0xa bank_mask:0xf
    v_add_f32_dpp v42, v42, v42 row_bcast:15 row_mask:0xa bank_mask:0xf
    s_nop 0
    v_add_f32_dpp v44, v44, v44 row_bcast:31 row_mask:0xc bank_mask:0xf
    v_add_f32_dpp v42, v42, v42 row_bcast:31 row_mask:0xc bank_mask:0xf
    v_mul_f32 v44, s48, v44
    v_mul_f32 v42, s48, v42
    v_fma_f32 v42, -v44, v44, v42
    v_max_f32 v42, 0, v42
    v_fma_f32 v42, v42, s49, v2
    v_rsq_f32 v42, v42
    v_pk_add_f32 v[46:47], v[94:95], v[44:45] op_sel_hi:[1,0] neg_lo:[0,1] neg_hi:[0,1]
    v_pk_mul_f32 v[92:93], v[46:47], v[42:43] op_sel_hi:[1,0]
    s_mov_b64 exec, s[34:35]
    ds_write_b128 v1, v[92:95] offset:5648
    s_waitcnt lgkmcnt(0)
    s_barrier
    s_endpgm
L_F:
    s_lshl_b32 s12, s3, 16
    s_lshl_b32 s11, s4, 6
    s_add_u32 s12, s12, s11
    s_add_u32 s12, s12, 131072
    v_lshrrev_b32 v2, 2, v0
    v_lshlrev_b32 v2, 11, v2
    v_and_b32 v3, 3, v0
    v_lshl_add_u32 v2, v3, 4, v2
    v_add_u32 v2, s12, v2
    v_add_u32 v3, 0x8000, v2
    s_cmp_eq_u32 s9, 1
    s_cselect_b64 s[46:47], -1, 0
    s_cselect_b64 s[48:49], 0, -1
    s_barrier
    ds_read_b128 v[32:35], v1 offset:10240
    ds_read_b128 v[36:39], v1 offset:12288
    ds_read_b128 v[40:43], v1 offset:14336
    ds_read_b128 v[44:47], v1 offset:16384
    ds_read_b128 v[48:51], v1 offset:18432
    ds_read_b128 v[52:55], v1 offset:20480
    ds_read_b128 v[56:59], v1 offset:22528
    ds_read_b128 v[60:63], v1 offset:11264
    ds_read_b128 v[112:115], v1 offset:13312
    ds_read_b128 v[116:119], v1 offset:15360
    ds_read_b128 v[120:123], v1 offset:17408
    ds_read_b128 v[124:127], v1 offset:19456
    ds_read_b128 v[12:15], v1 offset:21504
    ds_read_b128 v[16:19], v1 offset:23552
    s_waitcnt lgkmcnt(7)
    v_pk_add_f32 v[32:33], v[32:33], v[36:37]
    v_pk_add_f32 v[40:41], v[40:41], v[44:45]
    v_pk_add_f32 v[48:49], v[48:49], v[52:53]
    v_pk_add_f32 v[32:33], v[32:33], v[56:57]
    v_pk_add_f32 v[40:41], v[40:41], v[48:49]
    v_pk_add_f32 v[20:21], v[32:33], v[40:41]
    v_pk_add_f32 v[34:35], v[34:35], v[38:39]
    v_pk_add_f32 v[42:43], v[42:43], v[46:47]
    v_pk_add_f32 v[50:51], v[50:51], v[54:55]
    v_pk_add_f32 v[34:35], v[34:35], v[58:59]
    v_pk_add_f32 v[42:43], v[42:43], v[50:51]
    v_pk_add_f32 v[22:23], v[34:35], v[42:43]
    s_waitcnt lgkmcnt(0)
    v_pk_add_f32 v[60:61], v[60:61], v[112:113]
    v_pk_add_f32 v[116:117], v[116:117], v[120:121]
    v_pk_add_f32 v[124:125], v[124:125], v[12:13]
    v_pk_add_f32 v[60:61], v[60:61], v[16:17]
    v_pk_add_f32 v[116:117], v[116:117], v[124:125]
    v_pk_add_f32 v[24:25], v[60:61], v[116:117]
    v_pk_add_f32 v[62:63], v[62:63], v[114:115]
    v_pk_add_f32 v[118:119], v[118:119], v[122:123]
    v_pk_add_f32 v[126:127], v[126:127], v[14:15]
    v_pk_add_f32 v[62:63], v[62:63], v[18:19]
    v_pk_add_f32 v[118:119], v[118:119], v[126:127]
    v_pk_add_f32 v[26:27], v[62:63], v[118:119]
    s_waitcnt vmcnt(7)
    v_mfma_f32_16x16x32_bf16 v[20:23], v[96:99], v[64:67], v[20:23]
    s_waitcnt vmcnt(6)
    v_mfma_f32_16x16x32_bf16 v[24:27], v[96:99], v[68:71], v[24:27]
    s_waitcnt vmcnt(5)
    v_mfma_f32_16x16x32_bf16 v[20:23], v[100:103], v[72:75], v[20:23]
    s_waitcnt vmcnt(4)
    v_mfma_f32_16x16x32_bf16 v[24:27], v[100:103], v[76:79], v[24:27]
    s_waitcnt vmcnt(3)
    v_mfma_f32_16x16x32_bf16 v[20:23], v[104:107], v[80:83], v[20:23]
    s_waitcnt vmcnt(2)
    v_mfma_f32_16x16x32_bf16 v[24:27], v[104:107], v[84:87], v[24:27]
    s_waitcnt vmcnt(1)
    v_mfma_f32_16x16x32_bf16 v[20:23], v[108:111], v[88:91], v[20:23]
    s_waitcnt vmcnt(0)
    v_mfma_f32_16x16x32_bf16 v[24:27], v[108:111], v[92:95], v[24:27]
    s_nop 5
    v_and_b32 v20, -2, v20
    v_and_b32 v21, -2, v21
    v_and_b32 v22, -2, v22
    v_and_b32 v23, -2, v23
    s_mov_b64 exec, s[46:47]
    global_store_dwordx4 v2, v[20:23], s[40:41]
    s_mov_b64 exec, -1
    v_and_b32 v24, -2, v24
    v_and_b32 v25, -2, v25
    v_and_b32 v26, -2, v26
    v_and_b32 v27, -2, v27
    s_mov_b64 exec, s[46:47]
    global_store_dwordx4 v3, v[24:27], s[40:41]
    s_mov_b64 exec, s[48:49]
    global_store_dwordx4 v2, v[20:23], s[40:41] sc1
    global_store_dwordx4 v3, v[24:27], s[40:41] sc1
    s_endpgm
L_T_poll:
    s_sub_u32 s10, s10, 1
    s_cbranch_scc1 L_T_got
    global_load_dword v44, v15, s[40:41] sc1
    s_waitcnt vmcnt(0)
    s_branch L_T_chk
L_H_far:
    s_waitcnt vmcnt(0)
    v_xor_b32 v2, 1179648, v3
    s_mov_b64 exec, s[50:51]
    global_store_dwordx4 v2, v[8:11], s[40:41] sc1
    s_mov_b64 exec, -1
    s_mov_b32 s10, 1048576
L_H_gpoll:
    s_sub_u32 s10, s10, 1
    s_cbranch_scc1 L_H_got
    v_xor_b32 v12, 1179648, v12
    global_load_dwordx4 v[64:67], v12, s[40:41] offset:-4096 sc1
    global_load_dwordx4 v[68:71], v12, s[40:41] offset:-3072 sc1
    global_load_dwordx4 v[72:75], v12, s[40:41] offset:-2048 sc1
    global_load_dwordx4 v[76:79], v12, s[40:41] offset:-1024 sc1
    global_load_dwordx4 v[80:83], v12, s[40:41] offset:0 sc1
    global_load_dwordx4 v[84:87], v12, s[40:41] offset:1024 sc1
    global_load_dwordx4 v[88:91], v12, s[40:41] offset:2048 sc1
    global_load_dwordx4 v[92:95], v12, s[40:41] offset:3072 sc1
    s_waitcnt vmcnt(0)
    v_xor_b32 v16, s15, v65
    v_xor_b32 v17, s15, v69
    v_xor_b32 v18, s15, v73
    v_xor_b32 v19, s15, v77
    v_xor_b32 v20, s15, v81
    v_xor_b32 v21, s15, v85
    v_xor_b32 v22, s15, v89
    v_xor_b32 v23, s15, v93
    v_bitop3_b32 v16, v67, s15, v16 bitop3:0xbe
    v_bitop3_b32 v17, v71, s15, v17 bitop3:0xbe
    v_bitop3_b32 v18, v75, s15, v18 bitop3:0xbe
    v_bitop3_b32 v19, v79, s15, v19 bitop3:0xbe
    v_bitop3_b32 v20, v83, s15, v20 bitop3:0xbe
    v_bitop3_b32 v21, v87, s15, v21 bitop3:0xbe
    v_bitop3_b32 v22, v91, s15, v22 bitop3:0xbe
    v_bitop3_b32 v23, v95, s15, v23 bitop3:0xbe
    v_cmp_lt_u32 s[18:19], 15, v16
    v_cmp_lt_u32 s[20:21], 15, v17
    v_cmp_lt_u32 s[22:23], 15, v18
    v_cmp_lt_u32 s[24:25], 15, v19
    v_cmp_lt_u32 s[26:27], 15, v20
    v_cmp_lt_u32 s[28:29], 15, v21
    v_cmp_lt_u32 s[30:31], 15, v22
    v_cmp_lt_u32 s[32:33], 15, v23
    v_or3_b32 v4, v16, v17, v18
    v_or3_b32 v5, v19, v20, v21
    v_or3_b32 v4, v4, v22, v23
    v_or_b32 v4, v4, v5
    v_cmp_lt_u32 vcc, 15, v4
    s_cbranch_vccnz L_H_gpoll
    s_branch L_H_got
L_H_span:
    s_waitcnt vmcnt(0) lgkmcnt(0)
    v_xor_b32 v2, 1179648, v3
    s_mov_b64 exec, s[50:51]
    global_store_dwordx4 v2, v[8:11], s[40:41] sc1
    s_mov_b64 exec, -1
    v_mov_b32 v4, -2
    v_mov_b32 v5, -2
    v_mov_b32 v6, -2
    v_mov_b32 v7, -2
    s_lshl_b32 s11, s6, 11
    s_add_u32 s11, s11, 131072
    v_add_u32 v2, s11, v1
    global_store_dwordx4 v2, v[4:7], s[40:41] sc1
    global_store_dwordx4 v2, v[4:7], s[40:41] offset:1024 sc1
    s_waitcnt vmcnt(0)
    s_mov_b64 exec, 0xff
    v_add_u32 v2, 1212416, v1
    global_store_dwordx4 v2, v[8:11], s[54:55] sc1
    s_mov_b64 exec, -1
    s_lshl_b32 s11, s3, 12
    s_add_u32 s11, s11, 1212420
    v_and_b32 v2, 31, v0
    v_lshlrev_b32 v2, 7, v2
    v_add_u32 v2, s11, v2
    s_mov_b32 s10, 1048576
L_H_bpoll:
    s_sub_u32 s10, s10, 1
    s_cbranch_scc1 L_H_go
    global_load_dword v4, v2, s[40:41] sc1
    s_waitcnt vmcnt(0)
    v_xor_b32 v4, s14, v4
    v_cmp_lt_u32 vcc, 15, v4
    s_cbranch_vccnz L_H_bpoll
    s_branch L_H_go
L_exit:
    s_endpgm
.section .rodata,"a"
.p2align 6
.amdhsa_kernel sequential_preLN__sliding_block_cached__mixer_token_mlp__decode_kernel
  .amdhsa_next_free_vgpr 128
  .amdhsa_next_free_sgpr 102
  .amdhsa_accum_offset 128
  .amdhsa_group_segment_fixed_size 0
  .amdhsa_kernarg_size 104
  .amdhsa_user_sgpr_count 2
  .amdhsa_user_sgpr_kernarg_segment_ptr 1
  .amdhsa_system_sgpr_workgroup_id_x 1
  .amdhsa_float_denorm_mode_32 3
.end_amdhsa_kernel
```
